```python
import torch

def _softmax(x, axis=-1):
    return torch.softmax(x, dim=axis)

def _gelu(x):
    return torch.nn.functional.gelu(x, approximate='tanh')

def _silu(x):
    return torch.nn.functional.silu(x)

def _sigmoid(x):
    return torch.sigmoid(x)

def _layernorm(x, axis=-1, eps=1e-05):
    m = x.mean(dim=axis, keepdim=True)
    v = x.var(dim=axis, keepdim=True, unbiased=False)
    return (x - m) / torch.sqrt(v + eps)

def _scatter_add(tgt, idx, src, axis=0):
    return tgt.clone().index_add_(axis, idx, src)

def _segment_sum(src, seg, n):
    out = torch.zeros((n,) + src.shape[1:], dtype=src.dtype)
    return out.index_add_(0, seg, src)

def _pad(x, pw):
    flat = tuple((v for pair in reversed(pw) for v in pair))
    return torch.nn.functional.pad(x, flat)
kernel_name = 'adaLN_cond__sliding_local_dilated__mixer_channel_mlp__prompt'

def setup_inputs():

    _w = lambda a: (lambda t: t.to(torch.bfloat16) if t.is_floating_point() else t)(torch.as_tensor(a))

    def _A_setup():
        B, S, D = (1, 2048, 448)
        return {'x': _w((lambda *s: torch.randn(*s, dtype=torch.bfloat16) * 0.05)(B, S, D)), 'wqkv': _w((lambda *s: torch.randn(*s, dtype=torch.bfloat16) * 0.05)(D, 3 * D)), 'wo': _w((lambda *s: torch.randn(*s, dtype=torch.bfloat16) * 0.05)(D, D))}
    _A_in = _A_setup()

    def _B_setup():
        B, S, D, F = (1, 2048, 448, 1792)
        return {'x': _w((lambda *s: torch.randn(*s, dtype=torch.bfloat16) * 0.05)(B, S, D)), 'w1': _w((lambda *s: torch.randn(*s, dtype=torch.bfloat16) * 3.2)(D, F) * D ** (-0.5)), 'b1': _w((lambda *s: torch.randn(*s, dtype=torch.bfloat16) * 1.6)(F)), 'w2': _w((lambda *s: torch.randn(*s, dtype=torch.bfloat16) * 0.2)(F, D) * F ** (-0.5)), 'b2': _w((lambda *s: torch.randn(*s, dtype=torch.bfloat16) * 0.4)(D))}
    _B_in = _B_setup()
    return {'A_x': _A_in['x'], 'A_wqkv': _A_in['wqkv'], 'A_wo': _A_in['wo'], 'B_x': _B_in['x'], 'B_w1': _B_in['w1'], 'B_b1': _B_in['b1'], 'B_w2': _B_in['w2'], 'B_b2': _B_in['b2'], 'c': _w((lambda *s: torch.randn(*s, dtype=torch.bfloat16) * 0.1)(1, 448) * 8.0), 'w_mod': _w((lambda *s: torch.randn(*s, dtype=torch.bfloat16) * 0.1)(448, 6 * 448) * 448 ** (-0.5) * 8.0)}

def reference(A_x, A_wqkv, A_wo, B_x, B_w1, B_b1, B_w2, B_b2, c, w_mod):

    def _A_ref(x, wqkv, wo):
        B, S, D = x.shape
        H = 16
        Dh = D // H
        W, dil = (8, 2)
        qkv = (lambda x, *d: x.permute(*d))((x @ wqkv).reshape(B, S, 3, H, Dh), 2, 0, 3, 1, 4)
        q, k, v = (qkv[0], qkv[1], qkv[2])
        scale = Dh ** (-0.5)
        pos = torch.arange(S)
        off = torch.arange(W) * dil
        idx = pos[:, None] - off[None, :]
        mask = idx >= 0
        idx_c = torch.where(mask, idx, 0).reshape(-1)
        kg = k[:, :, idx_c, :].reshape(B, H, S, W, Dh)
        vg = v[:, :, idx_c, :].reshape(B, H, S, W, Dh)
        logits = torch.einsum('bhsd,bhswd->bhsw', q, kg) * scale
        logits = torch.where(mask[None, None, :, :], logits, -1000000000.0)
        attn = _softmax(logits, axis=-1)
        o = torch.einsum('bhsw,bhswd->bhsd', attn, vg)
        return (lambda x, *d: x.permute(*d))(o, 0, 2, 1, 3).reshape(B, S, D) @ wo

    def _B_ref(x, w1, b1, w2, b2):
        y = _layernorm(x, axis=-1)
        h = _gelu(torch.einsum('bsd,df->bsf', y, w1) + b1)
        return torch.einsum('bsf,fd->bsd', h, w2) + b2
    x = A_x
    mod = (_silu(c) @ w_mod).reshape(c.shape[0], 6, 1, -1)
    sa, ca, ga, sb, cb, gb = (mod[:, 0].clone(), mod[:, 1].clone(), mod[:, 2].clone(), mod[:, 3].clone(), mod[:, 4].clone(), mod[:, 5].clone())
    h = _layernorm(x, axis=-1) * (1 + ca) + sa
    x = x + ga * _A_ref(h, A_wqkv, A_wo)
    h = _layernorm(x, axis=-1) * (1 + cb) + sb
    x = x + gb * _B_ref(h, B_w1, B_b1, B_w2, B_b2)
    return x
```

```asm
; @launch grid=(256,1,1) block=(256,1,1) lds=163840
.amdgcn_target "amdgcn-amd-amdhsa--gfx950"
.text
.globl adaLN_cond__sliding_local_dilated__mixer_channel_mlp__prompt_kernel
.p2align 12
.p2align 8
.type adaLN_cond__sliding_local_dilated__mixer_channel_mlp__prompt_kernel,@function
adaLN_cond__sliding_local_dilated__mixer_channel_mlp__prompt_kernel:
    s_load_dwordx16 s[72:87], s[0:1], 0
    s_load_dwordx8 s[88:95], s[0:1], 64
    s_load_dwordx2 s[32:33], s[0:1], 96
    s_cmp_ge_u32 s2, 256
    s_cbranch_scc1 L_END
    s_getpc_b64 s[62:63]
L_PC:
    v_and_b32 v30, 15, v0
    s_lshr_b32 s64, s2, 3
    v_lshl_add_u32 v30, s64, 4, v30
    v_lshlrev_b32 v30, 7, v30
    v_min_u32 v30, L_END-L_PC, v30
    s_mov_b64 exec, 0xffff
    global_load_dword v26, v30, s[62:63]
    s_mov_b64 exec, -1
    v_mov_b32 v1, v0
    v_lshrrev_b32 v29, 6, v0
    v_and_b32 v0, 63, v0
    v_readfirstlane_b32 s44, v29
    s_mov_b32 s6, 1835008
    s_mov_b32 s7, 0x20000
    s_mov_b32 s10, 1204224
    s_mov_b32 s11, 0x20000
    s_mov_b32 s14, 401408
    s_mov_b32 s15, 0x20000
    s_mov_b32 s18, 1605632
    s_mov_b32 s19, 0x20000
    s_mov_b32 s22, 1605632
    s_mov_b32 s23, 0x20000
    s_mov_b32 s26, 2408448
    s_mov_b32 s27, 0x20000
    s_mov_b32 s30, 1835008
    s_mov_b32 s31, 0x20000
    s_mov_b32 s34, 16777216
    s_mov_b32 s35, 0x20000
    s_and_b32 s42, s2, 15
    s_lshr_b32 s43, s2, 4
    s_mul_i32 s48, s42, 458752
    s_add_u32 s48, s48, 1048576
    s_lshl_b32 s54, s44, 12
    v_lshlrev_b32 v2, 4, v0
    v_mov_b32 v23, 0
    v_lshrrev_b32 v29, 3, v0
    v_and_b32 v30, 2, v29
    v_lshrrev_b32 v29, 2, v29
    v_or_b32 v30, v30, v29
    v_and_b32 v29, 7, v0
    v_lshlrev_b32 v30, 1, v30
    v_xor_b32 v30, v30, v29
    v_lshlrev_b32 v31, 4, v30
    v_lshrrev_b32 v9, 3, v0
    v_mul_u32_u24 v8, 5376, v9
    v_add_u32 v8, v8, v31
    v_add_u32 v9, 41984, v8
    v_add_u32 v10, 83968, v8
    v_add_u32 v11, 125952, v8
    s_sub_u32 s3, s2, 144
    s_and_b32 s62, s3, 3
    s_lshr_b32 s63, s3, 2
    s_mul_i32 s64, s62, 112
    s_lshl_b32 s65, s44, 5
    s_add_u32 s65, s65, s64
    s_mul_i32 s65, s65, 5376
    s_lshl_b32 s66, s63, 7
    s_add_u32 s65, s65, s66
    v_min_u32 v29, 55, v0
    s_lshl_b32 s64, s64, 1
    v_lshl_add_u32 v29, v29, 2, s64
    s_sub_u32 s62, s2, 88
    s_cmp_lt_u32 s2, 144
    s_cselect_b32 s62, s2, s62
    s_lshl_b32 s62, s62, 2
    s_add_u32 s62, s62, s44
    s_mul_i32 s67, s62, 1792
    s_lshl_b32 s62, s62, 7
    s_add_u32 s96, s62, 11010048
    s_sub_u32 s62, s2, 112
    s_cmp_lt_u32 s62, 88
    s_cselect_b32 s67, 16777216, s67
    s_cselect_b32 s96, 16777216, s96
    v_lshrrev_b32 v33, 3, v0
    v_bfe_u32 v34, v0, 2, 1
    v_and_b32 v35, 3, v0
    v_mul_u32_u24 v36, 56, v33
    v_mul_u32_u24 v34, 896, v34
    v_lshl_add_u32 v36, v35, 4, v36
    v_add_u32 v36, v36, v34
    s_waitcnt lgkmcnt(0)
    s_mov_b64 s[24:25], s[90:91]
    s_mov_b64 exec, 1
    buffer_load_dword v3, off, s[32:35], 0 sc1
    s_mov_b64 exec, -1
    s_cmp_lt_u32 s2, 144
    s_cbranch_scc1 RI_1
    s_cmp_lt_u32 s2, 200
    s_cbranch_scc0 RK_3
    global_load_dword v32, v29, s[88:89]
    s_add_u32 m0, s54, 86016
    s_nop 0
    buffer_load_dwordx4 v8, s[24:27], s65 offen offset:0 lds
    buffer_load_dwordx4 v9, s[24:27], s65 offen offset:1024 lds
    buffer_load_dwordx4 v10, s[24:27], s65 offen offset:2048 lds
    buffer_load_dwordx4 v11, s[24:27], s65 offen offset:3072 lds
    s_branch RC_2
RK_3:
    s_mov_b64 s[8:9], s[74:75]
    buffer_load_dwordx4 v[40:43], v36, s[8:11], s67 offen offset:0
    buffer_load_dwordx4 v[44:47], v36, s[8:11], s67 offen offset:448
    global_load_dword v32, v29, s[88:89]
    s_and_b32 s62, s2, 7
    s_lshl_b32 s62, s62, 14
    s_add_u32 s62, s62, s54
    s_add_u32 s62, s62, 655360
    s_lshl_b32 s64, s42, 12
    s_add_u32 s64, s64, 524288
    s_cmp_lt_u32 s2, 208
    s_cselect_b32 s62, s62, s64
    s_sub_u32 s63, s2, 208
    s_cmp_lt_u32 s63, 16
    s_cselect_b32 s62, s62, 16777216
    v_and_b32 v33, 31, v0
    v_lshlrev_b32 v33, 7, v33
    buffer_load_dword v26, v33, s[32:35], s62 offen sc1
    s_branch RC_2
RI_1:
    s_mov_b64 s[8:9], s[74:75]
    buffer_load_dwordx4 v[40:43], v36, s[8:11], s67 offen offset:0
    buffer_load_dwordx4 v[44:47], v36, s[8:11], s67 offen offset:448
    s_mov_b64 s[4:5], s[72:73]
    s_lshr_b32 s66, s43, 2
    s_lshl_b32 s66, s66, 6
    s_bfe_u32 s67, s43, 0x10001
    s_add_u32 s66, s66, s67
    s_and_b32 s67, s43, 1
    s_lshl_b32 s67, s67, 5
    s_add_u32 s66, s66, s67
    s_lshl_b32 s67, s44, 3
    s_add_u32 s66, s66, s67
    s_and_b32 s67, s44, 1
    s_lshl_b32 s67, s67, 3
    s_lshr_b32 s68, s44, 1
    s_add_u32 s67, s67, s68
    s_cmp_eq_u32 s42, 0
    s_cselect_b32 s68, 0, 16
    s_sub_u32 s67, s67, s68
    s_cmp_eq_u32 s43, 8
    s_cselect_b32 s66, s67, s66
    s_lshl_b32 s67, s42, 7
    s_add_u32 s66, s66, s67
    s_mul_i32 s66, s66, 896
    s_add_u32 m0, s54, 102400
    s_mov_b32 exec_hi, 0x00ffffff
    buffer_load_dwordx4 v2, s[4:7], s66 offen offset:0 lds
    s_add_u32 s66, s66, 768
    buffer_load_dwordx4 v2, s[4:7], s66 offen offset:1024 lds
    s_add_u32 s66, s66, 768
    buffer_load_dwordx4 v2, s[4:7], s66 offen offset:2048 lds
    s_add_u32 s66, s66, 768
    buffer_load_dwordx4 v2, s[4:7], s66 offen offset:3072 lds
    s_mov_b32 exec_hi, -1
RC_2:
    s_mov_b64 s[4:5], s[72:73]
    s_mov_b64 s[8:9], s[74:75]
    s_mov_b64 s[12:13], s[76:77]
    s_mov_b64 s[16:17], s[80:81]
    s_mov_b64 s[36:37], s[82:83]
    s_mov_b64 s[20:21], s[84:85]
    s_mov_b64 s[38:39], s[86:87]
    s_mov_b64 s[28:29], s[92:93]
    v_lshrrev_b32 v33, 4, v0
    v_bfe_u32 v34, v0, 2, 2
    v_and_b32 v35, 3, v0
    v_lshlrev_b32 v35, 3, v35
    v_lshl_add_u32 v35, v34, 7, v35
    v_and_b32 v34, 2, v34
    v_and_b32 v36, 1, v33
    v_lshrrev_b32 v37, 1, v33
    v_lshl_add_u32 v38, v37, 11, v35
    v_lshl_add_u32 v38, v36, 9, v38
    v_or_b32 v39, v34, v36
    v_lshl_add_u32 v12, v39, 5, v38
    v_xor_b32 v13, 32, v12
    v_xor_b32 v14, 64, v12
    v_xor_b32 v15, 96, v12
    v_lshl_add_u32 v38, v37, 9, v35
    v_or_b32 v39, v34, v37
    v_xor_b32 v39, v39, v36
    v_lshl_add_u32 v16, v39, 5, v38
    v_add_u32 v16, 28672, v16
    v_xor_b32 v17, 64, v16
    s_sub_u32 s62, 15, s43
    s_cmp_lt_u32 s42, 8
    s_cselect_b32 s45, s43, s62
    s_mul_i32 s88, s44, 21504
    s_mul_i32 s62, s45, 86016
    s_add_u32 s62, s62, s88
    s_add_u32 s70, s62, 11010048
    s_add_u32 s62, s88, 56
    v_lshl_add_u32 v19, v0, 6, s62
    s_and_b32 s64, s2, 7
    s_cmp_lt_u32 s43, 9
    s_cselect_b32 s63, 0, 0
    s_add_u32 s64, s64, s63
    s_lshl_b32 s64, s64, 2
    s_mov_b32 s62, 0x21043210
    s_mov_b32 s63, 0x04321043
    s_lshr_b64 s[62:63], s[62:63], s64
    s_bfe_u32 s64, s62, 262144
    s_lshl_b32 s75, s64, 12
    s_bfe_u32 s64, s62, 262148
    s_lshl_b32 s76, s64, 12
    s_bfe_u32 s64, s62, 262152
    s_lshl_b32 s77, s64, 12
    s_bfe_u32 s64, s62, 262156
    s_lshl_b32 s78, s64, 12
    s_bfe_u32 s64, s62, 262160
    s_lshl_b32 s79, s64, 12
    s_cmp_lt_u32 s2, 144
    s_cbranch_scc1 RJ_4
    s_lshl_b32 s62, s44, 5
    v_xor_b32 v140, s62, v12
    v_add_u32 v140, 102400, v140
    v_lshrrev_b32 v141, 5, v0
    v_bfe_u32 v142, v0, 4, 1
    v_lshlrev_b32 v141, 5, v141
    v_lshl_add_u32 v141, v142, 3, v141
    v_add_u32 v141, 118784, v141
    v_lshlrev_b32 v142, 2, v0
    v_add_u32 v143, 118784, v142
    s_and_b32 s62, s3, 3
    s_mul_i32 s62, s62, 10752
    s_lshr_b32 s63, s3, 2
    s_lshl_b32 s63, s63, 8
    s_add_u32 s62, s62, s63
    s_lshl_b32 s63, s44, 6
    s_add_u32 s62, s62, s63
    s_add_u32 s72, s62, 65536
    s_cmp_lt_u32 s2, 200
    s_cbranch_scc0 RN_5
    s_and_b32 s62, s44, 1
    s_lshl_b32 s63, s62, 6
    v_xor_b32 v145, s63, v12
    v_add_u32 v145, 86016, v145
    v_xor_b32 v146, 32, v145
    v_and_b32 v147, 31, v0
    v_lshlrev_b32 v147, 2, v147
    v_lshrrev_b32 v33, 5, v0
    v_lshl_add_u32 v147, v33, 14, v147
    s_lshl_b32 s62, s62, 7
    s_and_b32 s63, s3, 3
    s_mul_i32 s63, s63, 3584
    s_add_u32 s62, s62, s63
    s_lshr_b32 s63, s3, 2
    s_lshl_b32 s63, s63, 8
    s_add_u32 s62, s62, s63
    s_lshr_b32 s63, s44, 1
    s_lshl_b32 s63, s63, 16
    s_add_u32 s62, s62, s63
    s_add_u32 s74, s62, 655360
    s_waitcnt vmcnt(5)
    v_readfirstlane_b32 s46, v3
    s_nop 0
    s_add_u32 s46, s46, 0x01010101
    v_mov_b32 v3, s46
    s_and_b32 s40, s46, 0xbfffbfff
    v_cmp_gt_u32 vcc, 56, v0
    v_lshlrev_b32 v144, 3, v0
    v_bfe_u32 v144, v3, v144, 8
    s_waitcnt vmcnt(4)
    v_lshlrev_b32 v34, 16, v32
    v_and_b32 v35, 0xffff0000, v32
    v_mul_f32 v36, 0xbfb8aa3b, v34
    v_mul_f32 v37, 0xbfb8aa3b, v35
    v_exp_f32 v36, v36
    v_exp_f32 v37, v37
    v_add_f32 v36, 1.0, v36
    v_add_f32 v37, 1.0, v37
    v_rcp_f32 v36, v36
    v_rcp_f32 v37, v37
    v_mul_f32 v34, v34, v36
    v_mul_f32 v35, v35, v37
    v_cvt_pk_bf16_f32 v34, v34, v35
    v_cndmask_b32 v34, 0, v34, vcc
    ds_write_b32 v143, v34
    ds_read_b64 v[120:121], v141 offset:0
    ds_read_b64 v[122:123], v141 offset:16
    ds_read_b64 v[124:125], v141 offset:64
    ds_read_b64 v[126:127], v141 offset:80
    ds_read_b64 v[128:129], v141 offset:128
    ds_read_b64 v[130:131], v141 offset:144
    ds_read_b64 v[132:133], v141 offset:192
    ds_read_b64 v[134:135], v141 offset:208
    s_mov_b32 s73, 0xffffff00
    s_mov_b32 s62, 0xffff0000
    s_mov_b32 s63, 0xffff0000
    s_add_u32 s64, s74, 32768
    s_waitcnt vmcnt(0)
    s_barrier
    ds_read_b64_tr_b16 v[88:89], v145 offset:0
    ds_read_b64_tr_b16 v[90:91], v145 offset:1024
    ds_read_b64_tr_b16 v[92:93], v146 offset:0
    ds_read_b64_tr_b16 v[94:95], v146 offset:1024
    ds_read_b64_tr_b16 v[96:97], v145 offset:4096
    ds_read_b64_tr_b16 v[98:99], v145 offset:5120
    ds_read_b64_tr_b16 v[100:101], v146 offset:4096
    ds_read_b64_tr_b16 v[102:103], v146 offset:5120
    ds_read_b64_tr_b16 v[104:105], v145 offset:8192
    ds_read_b64_tr_b16 v[106:107], v145 offset:9216
    ds_read_b64_tr_b16 v[108:109], v146 offset:8192
    ds_read_b64_tr_b16 v[110:111], v146 offset:9216
    ds_read_b64_tr_b16 v[112:113], v145 offset:12288
    ds_read_b64_tr_b16 v[114:115], v145 offset:13312
    ds_read_b64_tr_b16 v[116:117], v146 offset:12288
    ds_read_b64_tr_b16 v[118:119], v146 offset:13312
    s_waitcnt lgkmcnt(12)
    v_mfma_f32_16x16x32_bf16 v[80:83], v[120:123], v[88:91], 0
    v_mfma_f32_16x16x32_bf16 v[84:87], v[120:123], v[92:95], 0
    s_waitcnt lgkmcnt(8)
    v_mfma_f32_16x16x32_bf16 v[80:83], v[124:127], v[96:99], v[80:83]
    v_mfma_f32_16x16x32_bf16 v[84:87], v[124:127], v[100:103], v[84:87]
    s_waitcnt lgkmcnt(4)
    v_mfma_f32_16x16x32_bf16 v[80:83], v[128:131], v[104:107], v[80:83]
    v_mfma_f32_16x16x32_bf16 v[84:87], v[128:131], v[108:111], v[84:87]
    s_waitcnt lgkmcnt(0)
    v_mfma_f32_16x16x32_bf16 v[80:83], v[132:135], v[112:115], v[80:83]
    v_mfma_f32_16x16x32_bf16 v[84:87], v[132:135], v[116:119], v[84:87]
    s_nop 7
    v_cndmask_b32 v80, v80, v84, s[62:63]
    v_and_or_b32 v80, v80, s73, v144
    buffer_store_dword v80, v147, s[32:35], s74 offen sc1
    buffer_store_dword v80, v147, s[32:35], s64 offen sc1
    s_branch RX_6
RN_5:
    v_lshrrev_b32 v33, 3, v0
    v_mul_u32_u24 v64, 86016, v33
    v_and_b32 v35, 7, v0
    v_lshl_add_u32 v64, v35, 4, v64
    v_and_b32 v35, 3, v0
    v_cmp_eq_u32 vcc, 3, v35
    s_add_u32 s97, s96, 688128
    s_waitcnt vmcnt(4)
    v_readfirstlane_b32 s46, v3
    s_nop 0
    s_add_u32 s46, s46, 0x01010101
    v_mov_b32 v3, s46
    s_and_b32 s40, s46, 0xbfffbfff
    v_mov_b32 v65, s40
    s_waitcnt vmcnt(3)
    v_cndmask_b32 v43, v43, v65, vcc
    buffer_store_dwordx4 v[40:43], v64, s[32:35], s96 offen sc1
    s_waitcnt vmcnt(3)
    v_cndmask_b32 v47, v47, v65, vcc
    buffer_store_dwordx4 v[44:47], v64, s[32:35], s97 offen sc1
    s_sub_u32 s62, s2, 200
    s_lshl_b32 s62, s62, 2
    s_add_u32 s62, s62, s44
    s_mul_i32 s62, s62, 1792
    v_min_u32 v33, 13, v0
    v_lshlrev_b32 v33, 7, v33
    buffer_load_dword v26, v33, s[12:15], s62 offen
    v_cmp_gt_u32 vcc, 56, v0
    v_lshlrev_b32 v144, 3, v0
    v_bfe_u32 v144, v3, v144, 8
    s_waitcnt vmcnt(4)
    v_lshlrev_b32 v34, 16, v32
    v_and_b32 v35, 0xffff0000, v32
    v_mul_f32 v36, 0xbfb8aa3b, v34
    v_mul_f32 v37, 0xbfb8aa3b, v35
    v_exp_f32 v36, v36
    v_exp_f32 v37, v37
    v_add_f32 v36, 1.0, v36
    v_add_f32 v37, 1.0, v37
    v_rcp_f32 v36, v36
    v_rcp_f32 v37, v37
    v_mul_f32 v34, v34, v36
    v_mul_f32 v35, v35, v37
    v_cvt_pk_bf16_f32 v34, v34, v35
    v_cndmask_b32 v34, 0, v34, vcc
    ds_write_b32 v143, v34
    ds_read_b64 v[120:121], v141 offset:0
    ds_read_b64 v[122:123], v141 offset:16
    ds_read_b64 v[124:125], v141 offset:64
    ds_read_b64 v[126:127], v141 offset:80
    ds_read_b64 v[128:129], v141 offset:128
    ds_read_b64 v[130:131], v141 offset:144
    ds_read_b64 v[132:133], v141 offset:192
    ds_read_b64 v[134:135], v141 offset:208
    s_branch RX_6
RJ_4:
    s_lshr_b32 s62, s43, 1
    s_mul_i32 s62, s62, 114688
    s_and_b32 s63, s43, 1
    s_lshl_b32 s63, s63, 2
    s_add_u32 s63, s63, s44
    s_mul_i32 s63, s63, 3584
    s_add_u32 s62, s62, s63
    s_cmp_eq_u32 s43, 8
    s_mov_b32 s63, 86016
    s_cselect_b32 s63, -425984, s63
    s_add_u32 s62, s62, s63
    s_add_u32 s49, s62, s48
    s_lshl_b32 s63, s42, 12
    s_lshl_b32 s64, s43, 4
    s_add_u32 s63, s63, s64
    s_lshl_b32 s64, s44, 2
    s_add_u32 s63, s63, s64
    s_add_u32 s41, s63, 524288
    v_min_u32 v163, 27, v0
    v_lshlrev_b32 v163, 7, v163
    v_and_b32 v160, 3, v0
    v_lshrrev_b32 v161, 2, v0
    v_lshlrev_b32 v160, 10, v160
    v_lshl_add_u32 v160, v161, 4, v160
    s_add_u32 s62, s54, 102400
    v_add_u32 v160, s62, v160
    s_mul_i32 s63, s44, -3872
    v_add_u32 v159, s63, v160
    s_lshr_b32 s62, s54, 2
    s_add_u32 s62, s62, 119296
    v_lshl_add_u32 v161, v161, 5, s62
    v_add_u32 v162, s62, v2
    v_and_b32 v158, 3, v0
    v_lshlrev_b32 v158, 3, v158
    v_add_u32 v158, 118784, v158
    s_lshl_b32 s62, s44, 5
    v_add_u32 v157, s62, v158
    s_mul_i32 s84, s44, 114688
    s_add_u32 s84, s84, s48
    v_lshrrev_b32 v33, 4, v0
    v_bfe_u32 v34, v0, 2, 2
    v_and_b32 v35, 3, v0
    v_lshrrev_b32 v36, 5, v0
    v_and_b32 v37, 15, v0
    v_lshl_add_u32 v38, v36, 3, v34
    v_mul_u32_u24 v38, 192, v38
    v_and_b32 v39, 1, v33
    v_lshl_add_u32 v38, v39, 5, v38
    v_lshl_add_u32 v21, v35, 3, v38
    v_add_u32 v22, 43008, v21
    v_bfe_u32 v38, v0, 2, 3
    v_mul_u32_u24 v38, 3584, v38
    v_lshl_add_u32 v38, v36, 6, v38
    v_lshl_add_u32 v38, v35, 4, v38
    s_add_u32 s62, s84, 86016
    v_add_u32 v244, s62, v38
    v_mul_u32_u24 v38, 3584, v34
    v_lshl_add_u32 v38, v33, 6, v38
    v_lshl_add_u32 v38, v35, 4, v38
    s_and_b32 s63, s44, 1
    s_lshl_b32 s64, s44, 8
    s_add_u32 s62, s48, s64
    s_add_u32 s62, s62, 32768
    v_add_u32 v245, s62, v38
    v_lshl_add_u32 v38, v33, 3, v34
    v_mul_u32_u24 v38, 192, v38
    v_lshl_add_u32 v38, v35, 3, v38
    s_mul_i32 s62, s44, 6144
    v_add_u32 v246, s62, v38
    s_mul_i32 s62, s63, 6144
    s_add_u32 s62, s62, 73728
    v_add_u32 v247, s62, v38
    v_lshrrev_b32 v38, 3, v37
    v_lshlrev_b32 v38, 11, v38
    v_and_b32 v34, 7, v37
    v_lshl_add_u32 v38, v34, 4, v38
    v_lshl_add_u32 v38, v39, 9, v38
    v_lshl_add_u32 v38, v36, 3, v38
    s_lshl_b32 s62, s63, 10
    s_add_u32 s62, s62, 16768
    v_add_u32 v38, s62, v38
    v_lshlrev_b32 v34, 8, v33
    v_lshl_add_u32 v34, v37, 3, v34
    s_lshl_b32 s62, s63, 7
    s_add_u32 s62, s62, 158208
    v_add_u32 v34, s62, v34
    s_cmp_lt_u32 s44, 2
    s_cselect_b64 vcc, -1, 0
    s_cselect_b32 s93, 0, 16777216
    v_cndmask_b32 v248, v34, v38, vcc
    v_min_u32 v38, 11, v37
    s_lshl_b32 s62, s44, 3
    v_add_u32 v34, s62, v38
    v_cmp_gt_u32 vcc, 8, v38
    v_add_u32 v38, 24, v38
    s_lshl_b32 s62, s42, 12
    s_add_u32 s62, s62, 524288
    v_cndmask_b32 v34, v38, v34, vcc
    v_lshl_add_u32 v34, v34, 2, s62
    v_cmp_gt_u32 vcc, 32, v0
    s_lshl_b32 s62, s42, 11
    s_add_u32 s62, s62, 229376
    v_lshl_add_u32 v38, v37, 7, s62
    v_cndmask_b32 v184, v38, v34, vcc
    v_cndmask_b32 v249, 0, -1, vcc
    v_lshrrev_b32 v33, 3, v0
    v_mul_u32_u24 v64, 86016, v33
    v_and_b32 v35, 7, v0
    v_lshl_add_u32 v64, v35, 4, v64
    v_and_b32 v35, 3, v0
    v_cmp_eq_u32 vcc, 3, v35
    s_add_u32 s97, s96, 688128
    s_waitcnt vmcnt(6)
    v_readfirstlane_b32 s46, v3
    s_nop 0
    s_add_u32 s46, s46, 0x01010101
    v_mov_b32 v3, s46
    s_and_b32 s40, s46, 0xbfffbfff
    v_mov_b32 v65, s40
    s_waitcnt vmcnt(5)
    v_cndmask_b32 v43, v43, v65, vcc
    buffer_store_dwordx4 v[40:43], v64, s[32:35], s96 offen sc1
    s_waitcnt vmcnt(5)
    v_cndmask_b32 v47, v47, v65, vcc
    buffer_store_dwordx4 v[44:47], v64, s[32:35], s97 offen sc1
    s_getreg_b32 s50, hwreg(HW_REG_XCC_ID, 0, 3)
    s_andn2_b32 s63, s46, 7
    s_or_b32 s50, s50, s63
    v_mov_b32 v24, s50
    s_lshl_b32 s62, s42, 11
    s_lshl_b32 s64, s43, 7
    s_add_u32 s62, s62, s64
    s_add_u32 s62, s62, 229376
    s_cmp_eq_u32 s44, 0
    s_cselect_b32 s62, s62, 16777216
    s_mov_b64 exec, 1
    buffer_store_dword v24, off, s[32:35], s62 sc1
    s_mov_b64 exec, -1
    buffer_load_dword v26, v163, s[32:35], s49 offen sc1
    s_branch L_PG1
.p2align 12
L_PG1:
    v_cmp_le_u32 vcc, 28, v0
    v_min_u32 v23, 880, v2
    v_add_u32 v32, 1344, v23
    v_cndmask_b32 v23, v23, v32, vcc
    s_and_b32 s80, s2, 7
    s_lshl_b32 s80, s80, 14
    s_mul_i32 s81, s44, 448
    s_add_u32 s80, s80, s81
    s_add_u32 s80, s80, 655360
    s_add_u32 s81, s80, 3584
    s_add_u32 s82, s80, 7168
    s_add_u32 s83, s80, 10752
    v_cndmask_b32 v32, 0, 1.0, vcc
    v_bfe_u32 v180, v3, 0, 8
    v_bfe_u32 v181, v3, 8, 8
    v_bfe_u32 v182, v3, 16, 8
    v_bfe_u32 v183, v3, 24, 8
    v_lshrrev_b32 v36, 5, v0
    s_lshr_b32 s62, s54, 1
    v_add_u32 v250, s62, v2
    s_lshr_b32 s62, s54, 3
    s_add_u32 s62, s62, 158208
    v_lshl_add_u32 v251, v0, 3, s62
    s_lshr_b32 s62, s54, 2
    v_add_u32 v253, s62, v2
    v_add_u32 v254, s54, v2
    v_mov_b32 v252, 0x3f803f80
    v_mov_b32 v230, 0
    v_mov_b32 v231, 0
    v_mov_b32 v242, 0
    v_mov_b32 v243, 0
    v_and_b32 v38, 31, v0
    v_lshlrev_b32 v34, 2, v36
    v_sub_u32 v38, v38, v34
    v_add_u32 v38, 5, v38
    s_mov_b64 s[62:63], 0xff
    v_lshlrev_b64 v[34:35], v38, s[62:63]
    v_not_b32 v34, v34
    v_not_b32 v35, v35
    s_lshr_b32 s62, s44, 1
    s_or_b32 s62, s62, s42
    s_cmp_eq_u32 s62, 0
    s_cselect_b32 s62, 0xf0, 0
    v_or_b32 v34, s62, v34
    s_mov_b32 s62, 0xffff
    v_bfe_i32 v164, v34, 12, 1
    v_bfe_i32 v165, v34, 13, 1
    v_bitop3_b32 v232, s62, v164, v165 bitop3:0x35
    v_and_b32 v164, 0xf149f2ca, v164
    v_and_b32 v165, 0xf149f2ca, v165
    v_bfe_i32 v166, v34, 14, 1
    v_bfe_i32 v167, v34, 15, 1
    v_bitop3_b32 v233, s62, v166, v167 bitop3:0x35
    v_and_b32 v166, 0xf149f2ca, v166
    v_and_b32 v167, 0xf149f2ca, v167
    v_bfe_i32 v168, v34, 20, 1
    v_bfe_i32 v169, v34, 21, 1
    v_bitop3_b32 v234, s62, v168, v169 bitop3:0x35
    v_and_b32 v168, 0xf149f2ca, v168
    v_and_b32 v169, 0xf149f2ca, v169
    v_bfe_i32 v170, v34, 22, 1
    v_bfe_i32 v171, v34, 23, 1
    v_bitop3_b32 v235, s62, v170, v171 bitop3:0x35
    v_and_b32 v170, 0xf149f2ca, v170
    v_and_b32 v171, 0xf149f2ca, v171
    v_bfe_i32 v172, v34, 28, 1
    v_bfe_i32 v173, v34, 29, 1
    v_bitop3_b32 v236, s62, v172, v173 bitop3:0x35
    v_and_b32 v172, 0xf149f2ca, v172
    v_and_b32 v173, 0xf149f2ca, v173
    v_bfe_i32 v174, v34, 30, 1
    v_bfe_i32 v175, v34, 31, 1
    v_bitop3_b32 v237, s62, v174, v175 bitop3:0x35
    v_and_b32 v174, 0xf149f2ca, v174
    v_and_b32 v175, 0xf149f2ca, v175
    v_bfe_i32 v176, v35, 4, 1
    v_bfe_i32 v177, v35, 5, 1
    v_bitop3_b32 v238, s62, v176, v177 bitop3:0x35
    v_and_b32 v176, 0xf149f2ca, v176
    v_and_b32 v177, 0xf149f2ca, v177
    v_bfe_i32 v178, v35, 6, 1
    v_bfe_i32 v179, v35, 7, 1
    v_bitop3_b32 v239, s62, v178, v179 bitop3:0x35
    v_and_b32 v178, 0xf149f2ca, v178
    v_and_b32 v179, 0xf149f2ca, v179
    v_bfe_i32 v192, v34, 4, 1
    v_bfe_i32 v193, v34, 5, 1
    v_bitop3_b32 v240, s62, v192, v193 bitop3:0x35
    v_and_b32 v192, 0xf149f2ca, v192
    v_and_b32 v193, 0xf149f2ca, v193
    v_bfe_i32 v194, v34, 6, 1
    v_bfe_i32 v195, v34, 7, 1
    v_bitop3_b32 v241, s62, v194, v195 bitop3:0x35
    v_and_b32 v194, 0xf149f2ca, v194
    v_and_b32 v195, 0xf149f2ca, v195
    s_mov_b32 s62, 0xcba97531
    s_mov_b32 s63, 0x0086420d
    s_lshl_b32 s64, s43, 2
    s_lshr_b64 s[62:63], s[62:63], s64
    s_and_b32 s62, s62, 15
    s_sub_u32 s63, 13, s62
    s_cmp_lt_u32 s42, 8
    s_cselect_b32 s55, s62, s63
    s_and_b32 s51, s55, 1
    s_lshr_b32 s52, s55, 1
    s_sub_u32 s63, s2, 224
    s_min_u32 s63, s63, 27
    s_movk_i32 s60, 896
    s_mov_b32 s59, 0x20000
    s_cmp_lt_u32 s43, 14
    s_cselect_b64 s[56:57], s[12:13], s[16:17]
    s_cselect_b32 s58, s14, s18
    s_cselect_b32 s60, s60, 3584
    s_cselect_b32 s63, s52, s63
    s_lshl_b32 s63, s63, 7
    s_lshr_b32 s65, s42, 3
    s_lshl_b32 s64, s44, 1
    s_add_u32 s64, s64, s65
    s_mul_i32 s89, s64, 7168
    s_xor_b32 s62, s64, 1
    s_mul_i32 s61, s62, 7168
    s_mul_i32 s64, s64, 56
    s_mul_i32 s64, s64, s60
    s_add_u32 s87, s63, s64
    s_mul_i32 s65, s65, -112
    s_add_u32 s65, s65, 24
    s_mul_i32 s66, s65, s60
    s_mul_i32 s68, s65, 3584
    v_lshrrev_b32 v5, 3, v0
    v_mad_u32_u24 v4, v5, s60, v31
    s_lshl_b32 s62, s60, 3
    s_sub_u32 s62, s62, 1024
    v_add_u32 v5, s62, v4
    v_add_u32 v6, s62, v5
    v_add_u32 v7, s62, v6
    s_lshl_b32 s60, s60, 5
    v_lshrrev_b32 v29, 3, v0
    v_mul_u32_u24 v29, 1792, v29
    v_and_b32 v30, 7, v0
    v_lshl_add_u32 v28, v30, 4, v29
    s_lshl_b32 s62, s51, 1
    s_lshr_b32 s63, s44, 1
    s_add_u32 s62, s62, s63
    s_mul_i32 s85, s62, 114688
    s_add_u32 s85, s85, s48
    s_lshl_b32 s62, s42, 7
    s_lshl_b32 s64, s51, 6
    s_add_u32 s62, s62, s64
    s_add_u32 s62, s62, s63
    s_and_b32 s64, s44, 1
    s_lshl_b32 s64, s64, 5
    s_add_u32 s62, s62, s64
    s_mul_i32 s62, s62, 896
    s_lshl_b32 s64, s52, 7
    s_add_u32 s86, s62, s64
    v_lshl_add_u32 v20, v0, 1, s64
    v_lshrrev_b32 v29, 4, v0
    v_and_b32 v30, 15, v0
    v_lshlrev_b32 v30, 4, v30
    v_lshl_add_u32 v27, v29, 9, v30
    s_lshl_b32 s94, s45, 11
    s_add_u32 s94, s94, s84
    s_lshl_b32 s69, s42, 12
    s_add_u32 s69, s69, 524288
    s_lshl_b32 s63, s44, 7
    s_add_u32 s62, s69, s63
    s_lshl_b32 s63, s43, 2
    s_add_u32 s62, s62, s63
    s_add_u32 s95, s62, 256
    v_lshrrev_b32 v9, 3, v0
    v_mul_u32_u24 v8, 3584, v9
    v_add_u32 v8, v8, v31
    v_add_u32 v9, 27648, v8
    v_add_u32 v10, 55296, v8
    v_add_u32 v11, 82944, v8
    s_mul_i32 s62, s44, 1792
    s_lshl_b32 s63, s52, 8
    s_add_u32 s62, s62, s63
    v_lshl_add_u32 v31, v0, 2, s62
    v_lshlrev_b32 v29, 3, v0
    v_add_u32 v29, 143360, v29
    ds_write_b64 v29, v[230:231]
    s_and_b32 s62, s44, 1
    s_mul_i32 s62, s62, 3584
    s_lshl_b32 s63, s52, 9
    s_add_u32 s62, s62, s63
    s_add_u32 s62, s62, s85
    s_add_u32 s96, s62, 78848
    v_min_u32 v29, 19, v0
    v_cmp_gt_u32 vcc, 16, v0
    v_lshlrev_b32 v29, 7, v29
    v_add_u32 v185, s94, v29
    s_sub_u32 s62, s96, 2048
    v_add_u32 v29, s62, v29
    v_cndmask_b32 v185, v29, v185, vcc
    v_bfi_b32 v25, v249, v3, v24
    v_cmp_gt_u32 s[64:65], 56, v0
    s_waitcnt vmcnt(4)
    ds_read_b128 v[40:43], v160 offset:0
    ds_read_b128 v[44:47], v160 offset:224
    ds_read_b128 v[48:51], v160 offset:448
    ds_read_b128 v[52:55], v160 offset:672
    s_waitcnt lgkmcnt(3)
    v_lshlrev_b32 v64, 16, v40
    v_and_b32 v65, 0xffff0000, v40
    v_lshlrev_b32 v66, 16, v41
    v_and_b32 v67, 0xffff0000, v41
    v_lshlrev_b32 v68, 16, v42
    v_and_b32 v69, 0xffff0000, v42
    v_lshlrev_b32 v70, 16, v43
    v_and_b32 v71, 0xffff0000, v43
    s_waitcnt lgkmcnt(2)
    v_lshlrev_b32 v72, 16, v44
    v_and_b32 v73, 0xffff0000, v44
    v_lshlrev_b32 v74, 16, v45
    v_and_b32 v75, 0xffff0000, v45
    v_lshlrev_b32 v76, 16, v46
    v_and_b32 v77, 0xffff0000, v46
    v_lshlrev_b32 v78, 16, v47
    v_and_b32 v79, 0xffff0000, v47
    s_waitcnt lgkmcnt(1)
    v_lshlrev_b32 v80, 16, v48
    v_and_b32 v81, 0xffff0000, v48
    v_lshlrev_b32 v82, 16, v49
    v_and_b32 v83, 0xffff0000, v49
    v_lshlrev_b32 v84, 16, v50
    v_and_b32 v85, 0xffff0000, v50
    v_lshlrev_b32 v86, 16, v51
    v_and_b32 v87, 0xffff0000, v51
    s_waitcnt lgkmcnt(0)
    v_lshlrev_b32 v88, 16, v52
    v_and_b32 v89, 0xffff0000, v52
    v_lshlrev_b32 v90, 16, v53
    v_and_b32 v91, 0xffff0000, v53
    v_lshlrev_b32 v92, 16, v54
    v_and_b32 v93, 0xffff0000, v54
    v_lshlrev_b32_e64 v94, 16, v55
    v_and_b32 v95, 0xffff0000, v55
    v_pk_add_f32 v[36:37], v[64:65], v[66:67]
    v_pk_add_f32 v[36:37], v[36:37], v[68:69]
    v_pk_add_f32 v[36:37], v[36:37], v[70:71]
    v_pk_add_f32 v[36:37], v[36:37], v[72:73]
    v_pk_add_f32 v[36:37], v[36:37], v[74:75]
    v_pk_add_f32 v[36:37], v[36:37], v[76:77]
    v_pk_add_f32 v[36:37], v[36:37], v[78:79]
    v_pk_add_f32 v[36:37], v[36:37], v[80:81]
    v_pk_add_f32 v[36:37], v[36:37], v[82:83]
    v_pk_add_f32 v[36:37], v[36:37], v[84:85]
    v_pk_add_f32 v[36:37], v[36:37], v[86:87]
    v_pk_add_f32 v[36:37], v[36:37], v[88:89]
    v_pk_add_f32 v[36:37], v[36:37], v[90:91]
    v_pk_add_f32 v[36:37], v[36:37], v[92:93]
    v_pk_add_f32 v[36:37], v[36:37], v[94:95]
    v_add_f32 v36, v36, v37
    v_cndmask_b32 v36, 0, v36, s[64:65]
    s_nop 1
    v_add_f32_dpp v36, v36, v36 row_ror:4 row_mask:0xf bank_mask:0xf
    s_nop 1
    v_add_f32_dpp v36, v36, v36 row_ror:8 row_mask:0xf bank_mask:0xf
    v_mov_b32 v37, v36
    s_nop 1
    v_permlane16_swap_b32 v36, v37
    v_add_f32 v36, v36, v37
    v_mov_b32 v37, v36
    s_nop 1
    v_permlane32_swap_b32 v36, v37
    v_add_f32_e64 v36, v36, v37
    v_mul_f32 v38, 0x3b124925, v36
    v_pk_add_f32 v[64:65], v[64:65], v[38:39] op_sel_hi:[1,0] neg_lo:[0,1] neg_hi:[0,1]
    v_pk_add_f32 v[66:67], v[66:67], v[38:39] op_sel_hi:[1,0] neg_lo:[0,1] neg_hi:[0,1]
    v_pk_add_f32 v[68:69], v[68:69], v[38:39] op_sel_hi:[1,0] neg_lo:[0,1] neg_hi:[0,1]
    v_pk_add_f32 v[70:71], v[70:71], v[38:39] op_sel_hi:[1,0] neg_lo:[0,1] neg_hi:[0,1]
    v_pk_add_f32 v[72:73], v[72:73], v[38:39] op_sel_hi:[1,0] neg_lo:[0,1] neg_hi:[0,1]
    v_pk_add_f32 v[74:75], v[74:75], v[38:39] op_sel_hi:[1,0] neg_lo:[0,1] neg_hi:[0,1]
    v_pk_add_f32 v[76:77], v[76:77], v[38:39] op_sel_hi:[1,0] neg_lo:[0,1] neg_hi:[0,1]
    v_pk_add_f32 v[78:79], v[78:79], v[38:39] op_sel_hi:[1,0] neg_lo:[0,1] neg_hi:[0,1]
    v_pk_add_f32 v[80:81], v[80:81], v[38:39] op_sel_hi:[1,0] neg_lo:[0,1] neg_hi:[0,1]
    v_pk_add_f32 v[82:83], v[82:83], v[38:39] op_sel_hi:[1,0] neg_lo:[0,1] neg_hi:[0,1]
    v_pk_add_f32 v[84:85], v[84:85], v[38:39] op_sel_hi:[1,0] neg_lo:[0,1] neg_hi:[0,1]
    v_pk_add_f32 v[86:87], v[86:87], v[38:39] op_sel_hi:[1,0] neg_lo:[0,1] neg_hi:[0,1]
    v_pk_add_f32 v[88:89], v[88:89], v[38:39] op_sel_hi:[1,0] neg_lo:[0,1] neg_hi:[0,1]
    v_pk_add_f32 v[90:91], v[90:91], v[38:39] op_sel_hi:[1,0] neg_lo:[0,1] neg_hi:[0,1]
    v_pk_add_f32 v[92:93], v[92:93], v[38:39] op_sel_hi:[1,0] neg_lo:[0,1] neg_hi:[0,1]
    v_pk_add_f32 v[94:95], v[94:95], v[38:39] op_sel_hi:[1,0] neg_lo:[0,1] neg_hi:[0,1]
    v_pk_mul_f32 v[36:37], v[64:65], v[64:65]
    v_pk_fma_f32 v[36:37], v[66:67], v[66:67], v[36:37]
    v_pk_fma_f32 v[36:37], v[68:69], v[68:69], v[36:37]
    v_pk_fma_f32 v[36:37], v[70:71], v[70:71], v[36:37]
    v_pk_fma_f32 v[36:37], v[72:73], v[72:73], v[36:37]
    v_pk_fma_f32 v[36:37], v[74:75], v[74:75], v[36:37]
    v_pk_fma_f32 v[36:37], v[76:77], v[76:77], v[36:37]
    v_pk_fma_f32 v[36:37], v[78:79], v[78:79], v[36:37]
    v_pk_fma_f32 v[36:37], v[80:81], v[80:81], v[36:37]
    v_pk_fma_f32 v[36:37], v[82:83], v[82:83], v[36:37]
    v_pk_fma_f32 v[36:37], v[84:85], v[84:85], v[36:37]
    v_pk_fma_f32 v[36:37], v[86:87], v[86:87], v[36:37]
    v_pk_fma_f32 v[36:37], v[88:89], v[88:89], v[36:37]
    v_pk_fma_f32 v[36:37], v[90:91], v[90:91], v[36:37]
    v_pk_fma_f32 v[36:37], v[92:93], v[92:93], v[36:37]
    v_pk_fma_f32 v[36:37], v[94:95], v[94:95], v[36:37]
    v_add_f32 v36, v36, v37
    v_cndmask_b32 v36, 0, v36, s[64:65]
    s_nop 1
    v_add_f32_dpp v36, v36, v36 row_ror:4 row_mask:0xf bank_mask:0xf
    s_nop 1
    v_add_f32_dpp v36, v36, v36 row_ror:8 row_mask:0xf bank_mask:0xf
    v_mov_b32 v37, v36
    s_nop 1
    v_permlane16_swap_b32 v36, v37
    v_add_f32 v36, v36, v37
    v_mov_b32 v37, v36
    s_nop 1
    v_permlane32_swap_b32 v36, v37
    v_add_f32 v36, v36, v37
    v_mov_b32 v37, 0x3727c5ac
    v_fmac_f32 v37, 0x3b124925, v36
    v_rsq_f32 v39, v37
    s_nop 0
    ds_write_b64 v157, v[38:39]
    s_waitcnt lgkmcnt(0)
    s_barrier
    ds_read_b64 v[96:97], v158 offset:0
    ds_read_b128 v[40:43], v159 offset:0
    ds_read_b64 v[98:99], v158 offset:32
    ds_read_b128 v[44:47], v159 offset:4096
    ds_read_b64 v[100:101], v158 offset:64
    ds_read_b128 v[48:51], v159 offset:8192
    ds_read_b64 v[102:103], v158 offset:96
    ds_read_b128 v[52:55], v159 offset:12288
    s_waitcnt lgkmcnt(6)
    v_lshlrev_b32 v64, 16, v40
    v_and_b32 v65, 0xffff0000, v40
    v_lshlrev_b32 v66, 16, v41
    v_and_b32 v67, 0xffff0000, v41
    v_lshlrev_b32 v68, 16, v42
    v_and_b32 v69, 0xffff0000, v42
    v_lshlrev_b32 v70, 16, v43
    v_and_b32 v71, 0xffff0000, v43
    s_waitcnt lgkmcnt(4)
    v_lshlrev_b32 v72, 16, v44
    v_and_b32 v73, 0xffff0000, v44
    v_lshlrev_b32 v74, 16, v45
    v_and_b32 v75, 0xffff0000, v45
    v_lshlrev_b32 v76, 16, v46
    v_and_b32 v77, 0xffff0000, v46
    v_lshlrev_b32 v78, 16, v47
    v_and_b32 v79, 0xffff0000, v47
    s_waitcnt lgkmcnt(2)
    v_lshlrev_b32 v80, 16, v48
    v_and_b32 v81, 0xffff0000, v48
    v_lshlrev_b32 v82, 16, v49
    v_and_b32 v83, 0xffff0000, v49
    v_lshlrev_b32 v84, 16, v50
    v_and_b32 v85, 0xffff0000, v50
    v_lshlrev_b32 v86, 16, v51
    v_and_b32 v87, 0xffff0000, v51
    s_waitcnt lgkmcnt(0)
    v_lshlrev_b32 v88, 16, v52
    v_and_b32 v89, 0xffff0000, v52
    v_lshlrev_b32 v90, 16, v53
    v_and_b32 v91, 0xffff0000, v53
    v_lshlrev_b32 v92, 16, v54
    v_and_b32 v93, 0xffff0000, v54
    v_lshlrev_b32_e64 v94, 16, v55
    v_and_b32 v95, 0xffff0000, v55
    v_pk_add_f32 v[64:65], v[64:65], v[96:97] op_sel_hi:[1,0] neg_lo:[0,1] neg_hi:[0,1]
    v_pk_add_f32 v[66:67], v[66:67], v[96:97] op_sel_hi:[1,0] neg_lo:[0,1] neg_hi:[0,1]
    v_pk_add_f32 v[68:69], v[68:69], v[96:97] op_sel_hi:[1,0] neg_lo:[0,1] neg_hi:[0,1]
    v_pk_add_f32 v[70:71], v[70:71], v[96:97] op_sel_hi:[1,0] neg_lo:[0,1] neg_hi:[0,1]
    v_pk_mul_f32 v[64:65], v[64:65], v[96:97] op_sel:[0,1] op_sel_hi:[1,1]
    v_pk_mul_f32 v[66:67], v[66:67], v[96:97] op_sel:[0,1] op_sel_hi:[1,1]
    v_pk_mul_f32 v[68:69], v[68:69], v[96:97] op_sel:[0,1] op_sel_hi:[1,1]
    v_pk_mul_f32 v[70:71], v[70:71], v[96:97] op_sel:[0,1] op_sel_hi:[1,1]
    v_pk_add_f32 v[72:73], v[72:73], v[98:99] op_sel_hi:[1,0] neg_lo:[0,1] neg_hi:[0,1]
    v_pk_add_f32 v[74:75], v[74:75], v[98:99] op_sel_hi:[1,0] neg_lo:[0,1] neg_hi:[0,1]
    v_pk_add_f32 v[76:77], v[76:77], v[98:99] op_sel_hi:[1,0] neg_lo:[0,1] neg_hi:[0,1]
    v_pk_add_f32 v[78:79], v[78:79], v[98:99] op_sel_hi:[1,0] neg_lo:[0,1] neg_hi:[0,1]
    v_pk_mul_f32 v[72:73], v[72:73], v[98:99] op_sel:[0,1] op_sel_hi:[1,1]
    v_pk_mul_f32 v[74:75], v[74:75], v[98:99] op_sel:[0,1] op_sel_hi:[1,1]
    v_pk_mul_f32 v[76:77], v[76:77], v[98:99] op_sel:[0,1] op_sel_hi:[1,1]
    v_pk_mul_f32 v[78:79], v[78:79], v[98:99] op_sel:[0,1] op_sel_hi:[1,1]
    v_pk_add_f32 v[80:81], v[80:81], v[100:101] op_sel_hi:[1,0] neg_lo:[0,1] neg_hi:[0,1]
    v_pk_add_f32 v[82:83], v[82:83], v[100:101] op_sel_hi:[1,0] neg_lo:[0,1] neg_hi:[0,1]
    v_pk_add_f32 v[84:85], v[84:85], v[100:101] op_sel_hi:[1,0] neg_lo:[0,1] neg_hi:[0,1]
    v_pk_add_f32 v[86:87], v[86:87], v[100:101] op_sel_hi:[1,0] neg_lo:[0,1] neg_hi:[0,1]
    v_pk_mul_f32 v[80:81], v[80:81], v[100:101] op_sel:[0,1] op_sel_hi:[1,1]
    v_pk_mul_f32 v[82:83], v[82:83], v[100:101] op_sel:[0,1] op_sel_hi:[1,1]
    v_pk_mul_f32 v[84:85], v[84:85], v[100:101] op_sel:[0,1] op_sel_hi:[1,1]
    v_pk_mul_f32 v[86:87], v[86:87], v[100:101] op_sel:[0,1] op_sel_hi:[1,1]
    v_pk_add_f32 v[88:89], v[88:89], v[102:103] op_sel_hi:[1,0] neg_lo:[0,1] neg_hi:[0,1]
    v_pk_add_f32 v[90:91], v[90:91], v[102:103] op_sel_hi:[1,0] neg_lo:[0,1] neg_hi:[0,1]
    v_pk_add_f32 v[92:93], v[92:93], v[102:103] op_sel_hi:[1,0] neg_lo:[0,1] neg_hi:[0,1]
    v_pk_add_f32 v[94:95], v[94:95], v[102:103] op_sel_hi:[1,0] neg_lo:[0,1] neg_hi:[0,1]
    v_pk_mul_f32 v[88:89], v[88:89], v[102:103] op_sel:[0,1] op_sel_hi:[1,1]
    v_pk_mul_f32 v[90:91], v[90:91], v[102:103] op_sel:[0,1] op_sel_hi:[1,1]
    v_pk_mul_f32 v[92:93], v[92:93], v[102:103] op_sel:[0,1] op_sel_hi:[1,1]
    v_pk_mul_f32 v[94:95], v[94:95], v[102:103] op_sel:[0,1] op_sel_hi:[1,1]
    s_mul_i32 s62, s44, -2688
    s_add_u32 s49, s49, s62
    s_add_u32 s67, s49, 7168
    buffer_load_dwordx4 v[40:43], v23, s[32:35], s80 offen sc1
    buffer_load_dwordx4 v[44:47], v23, s[32:35], s81 offen sc1
    buffer_load_dwordx4 v[48:51], v23, s[32:35], s82 offen sc1
    buffer_load_dwordx4 v[52:55], v23, s[32:35], s83 offen sc1
    s_add_u32 m0, s88, s75
    s_add_u32 s71, s70, s75
    buffer_load_dwordx4 v2, s[32:35], s71 offen offset:0 sc1 lds
    buffer_load_dwordx4 v2, s[32:35], s71 offen offset:1024 sc1 lds
    buffer_load_dwordx4 v2, s[32:35], s71 offen offset:2048 sc1 lds
    buffer_load_dwordx4 v2, s[32:35], s71 offen offset:3072 sc1 lds
    s_mov_b64 exec, 0
    s_cmp_eq_u32 s44, 0
    s_cbranch_scc1 L_STUB0
    s_cmp_eq_u32 s44, 1
    s_cbranch_scc1 L_STUB1
    s_cmp_eq_u32 s44, 2
    s_cbranch_scc1 L_STUB2
    s_branch L_STUB3
L_BACKP:
    s_mov_b64 exec, -1
    s_mov_b32 s53, 40000
    s_waitcnt vmcnt(4)
    s_branch PL_8_w
PL_8:
    buffer_load_dwordx4 v[40:43], v23, s[32:35], s80 offen sc1
    buffer_load_dwordx4 v[44:47], v23, s[32:35], s81 offen sc1
    buffer_load_dwordx4 v[48:51], v23, s[32:35], s82 offen sc1
    buffer_load_dwordx4 v[52:55], v23, s[32:35], s83 offen sc1
    s_sub_u32 s53, s53, 1
    s_cbranch_scc1 L_END
    s_waitcnt vmcnt(0)
PL_8_w:
    s_nop 0
    v_bitop3_b32 v56, v40, v44, v180 bitop3:0x7e
    v_bitop3_b32 v60, v48, v52, v180 bitop3:0x7e
    v_bitop3_b32 v57, v41, v45, v181 bitop3:0x7e
    v_bitop3_b32 v61, v49, v53, v181 bitop3:0x7e
    v_bitop3_b32 v58, v42, v46, v182 bitop3:0x7e
    v_bitop3_b32 v62, v50, v54, v182 bitop3:0x7e
    v_bitop3_b32 v59, v43, v47, v183 bitop3:0x7e
    v_bitop3_b32 v63, v51, v55, v183 bitop3:0x7e
    v_or3_b32 v56, v56, v57, v58
    v_or3_b32 v59, v59, v60, v61
    v_or3_b32 v56, v56, v62, v63
    v_or_b32_e64 v56, v56, v59
    v_and_b32 v56, 0xff, v56
    v_cmp_eq_u32 vcc, 0, v56
    s_nop 0
    s_cmp_eq_u64 vcc, -1
    s_cbranch_scc0 PL_8
    v_and_b32 v40, 0xffffff00, v40
    v_and_b32 v41, 0xffffff00, v41
    v_and_b32 v42, 0xffffff00, v42
    v_and_b32 v43, 0xffffff00, v43
    v_and_b32 v44, 0xffffff00, v44
    v_and_b32 v45, 0xffffff00, v45
    v_and_b32 v46, 0xffffff00, v46
    v_and_b32 v47, 0xffffff00, v47
    v_and_b32 v48, 0xffffff00, v48
    v_and_b32 v49, 0xffffff00, v49
    v_and_b32 v50, 0xffffff00, v50
    v_and_b32 v51, 0xffffff00, v51
    v_and_b32 v52, 0xffffff00, v52
    v_and_b32 v53, 0xffffff00, v53
    v_and_b32 v54, 0xffffff00, v54
    v_and_b32 v55, 0xffffff00, v55
    v_pk_add_f32 v[40:41], v[40:41], v[48:49]
    v_pk_add_f32 v[42:43], v[42:43], v[50:51]
    v_pk_add_f32 v[44:45], v[44:45], v[52:53]
    v_pk_add_f32 v[46:47], v[46:47], v[54:55]
    v_pk_add_f32 v[40:41], v[40:41], v[44:45]
    v_pk_add_f32 v[42:43], v[42:43], v[46:47]
    v_cvt_pk_bf16_f32 v56, v40, v41
    v_cvt_pk_bf16_f32 v57, v42, v43
    v_lshlrev_b32 v40, 16, v56
    v_and_b32 v41, 0xffff0000, v56
    v_lshlrev_b32 v42, 16, v57
    v_and_b32 v43, 0xffff0000, v57
    v_pk_add_f32 v[40:41], v[40:41], v[32:33] op_sel_hi:[1,0]
    v_pk_add_f32 v[42:43], v[42:43], v[32:33] op_sel_hi:[1,0]
    v_cvt_pk_bf16_f32 v56, v40, v41
    v_cvt_pk_bf16_f32 v57, v42, v43
    v_lshlrev_b32 v40, 16, v56
    v_and_b32 v41, 0xffff0000, v56
    v_lshlrev_b32_e64 v42, 16, v57
    v_and_b32 v43, 0xffff0000, v57
    ds_write_b128 v162, v[40:43]
    ds_read_b128 v[96:99], v161 offset:0
    ds_read_b128 v[104:107], v161 offset:448
    ds_read_b128 v[100:103], v161 offset:16
    ds_read_b128 v[108:111], v161 offset:464
    s_mov_b32 exec_hi, 0x00ffffff
    s_waitcnt lgkmcnt(0)
    v_pk_fma_f32 v[64:65], v[64:65], v[104:105], v[96:97]
    v_pk_fma_f32 v[66:67], v[66:67], v[106:107], v[98:99]
    v_pk_fma_f32 v[68:69], v[68:69], v[108:109], v[100:101]
    v_pk_fma_f32 v[70:71], v[70:71], v[110:111], v[102:103]
    v_cvt_pk_bf16_f32 v40, v64, v65
    v_cvt_pk_bf16_f32 v41, v66, v67
    v_cvt_pk_bf16_f32 v42, v68, v69
    v_cvt_pk_bf16_f32 v43, v70, v71
    buffer_store_dwordx4 v[40:43], v2, s[32:35], s49 offen offset:0
    v_pk_fma_f32 v[72:73], v[72:73], v[104:105], v[96:97]
    v_pk_fma_f32 v[74:75], v[74:75], v[106:107], v[98:99]
    v_pk_fma_f32 v[76:77], v[76:77], v[108:109], v[100:101]
    v_pk_fma_f32 v[78:79], v[78:79], v[110:111], v[102:103]
    v_cvt_pk_bf16_f32 v44, v72, v73
    v_cvt_pk_bf16_f32 v45, v74, v75
    v_cvt_pk_bf16_f32 v46, v76, v77
    v_cvt_pk_bf16_f32 v47, v78, v79
    buffer_store_dwordx4 v[44:47], v2, s[32:35], s49 offen offset:3584
    v_pk_fma_f32 v[80:81], v[80:81], v[104:105], v[96:97]
    v_pk_fma_f32 v[82:83], v[82:83], v[106:107], v[98:99]
    v_pk_fma_f32 v[84:85], v[84:85], v[108:109], v[100:101]
    v_pk_fma_f32 v[86:87], v[86:87], v[110:111], v[102:103]
    v_cvt_pk_bf16_f32 v48, v80, v81
    v_cvt_pk_bf16_f32 v49, v82, v83
    v_cvt_pk_bf16_f32 v50, v84, v85
    v_cvt_pk_bf16_f32 v51, v86, v87
    buffer_store_dwordx4 v[48:51], v2, s[32:35], s67 offen offset:0
    v_pk_fma_f32 v[88:89], v[88:89], v[104:105], v[96:97]
    v_pk_fma_f32 v[90:91], v[90:91], v[106:107], v[98:99]
    v_pk_fma_f32 v[92:93], v[92:93], v[108:109], v[100:101]
    v_pk_fma_f32 v[94:95], v[94:95], v[110:111], v[102:103]
    v_cvt_pk_bf16_f32 v52, v88, v89
    v_cvt_pk_bf16_f32 v53, v90, v91
    v_cvt_pk_bf16_f32 v54, v92, v93
    v_cvt_pk_bf16_f32 v55, v94, v95
    buffer_store_dwordx4 v[52:55], v2, s[32:35], s67 offen offset:3584
    s_mov_b32 exec_hi, -1
    s_add_u32 m0, s88, s76
    s_add_u32 s71, s70, s76
    buffer_load_dwordx4 v2, s[32:35], s71 offen offset:0 sc1 lds
    buffer_load_dwordx4 v2, s[32:35], s71 offen offset:1024 sc1 lds
    buffer_load_dwordx4 v2, s[32:35], s71 offen offset:2048 sc1 lds
    buffer_load_dwordx4 v2, s[32:35], s71 offen offset:3072 sc1 lds
    s_mov_b64 exec, 1
    s_waitcnt vmcnt(4)
    buffer_store_dword v3, off, s[32:35], s41
    s_mov_b64 exec, -1
    s_add_u32 m0, s88, s77
    s_add_u32 s71, s70, s77
    buffer_load_dwordx4 v2, s[32:35], s71 offen offset:0 sc1 lds
    buffer_load_dwordx4 v2, s[32:35], s71 offen offset:1024 sc1 lds
    buffer_load_dwordx4 v2, s[32:35], s71 offen offset:2048 sc1 lds
    buffer_load_dwordx4 v2, s[32:35], s71 offen offset:3072 sc1 lds
    s_add_u32 m0, s88, s78
    s_add_u32 s71, s70, s78
    buffer_load_dwordx4 v2, s[32:35], s71 offen offset:0 sc1 lds
    buffer_load_dwordx4 v2, s[32:35], s71 offen offset:1024 sc1 lds
    buffer_load_dwordx4 v2, s[32:35], s71 offen offset:2048 sc1 lds
    buffer_load_dwordx4 v2, s[32:35], s71 offen offset:3072 sc1 lds
    s_add_u32 m0, s88, s79
    s_add_u32 s71, s70, s79
    buffer_load_dwordx4 v2, s[32:35], s71 offen offset:0 sc1 lds
    buffer_load_dwordx4 v2, s[32:35], s71 offen offset:1024 sc1 lds
    buffer_load_dwordx4 v2, s[32:35], s71 offen offset:2048 sc1 lds
    buffer_load_dwordx4 v2, s[32:35], s71 offen offset:3072 sc1 lds
    s_add_u32 m0, s88, 20480
    s_add_u32 s71, s70, 20480
    buffer_load_dwordx4 v2, s[32:35], s71 offen offset:0 sc1 lds
    s_branch RA_7
RX_6:
    s_add_u32 m0, s54, 102400
    s_add_u32 s65, s65, 1792
    buffer_load_dwordx4 v8, s[24:27], s65 offen offset:0 lds
    buffer_load_dwordx4 v9, s[24:27], s65 offen offset:1024 lds
    buffer_load_dwordx4 v10, s[24:27], s65 offen offset:2048 lds
    buffer_load_dwordx4 v11, s[24:27], s65 offen offset:3072 lds
    s_getreg_b32 s50, hwreg(HW_REG_XCC_ID, 0, 3)
    s_andn2_b32 s63, s46, 7
    s_or_b32 s50, s50, s63
    v_mov_b32 v24, s50
    s_lshl_b32 s62, s42, 11
    s_lshl_b32 s64, s43, 7
    s_add_u32 s62, s62, s64
    s_add_u32 s62, s62, 229376
    s_cmp_eq_u32 s44, 0
    s_cselect_b32 s62, s62, 16777216
    s_mov_b64 exec, 1
    buffer_store_dword v24, off, s[32:35], s62 sc1
    s_mov_b64 exec, -1
    s_mul_i32 s84, s44, 114688
    s_add_u32 s84, s84, s48
    v_lshrrev_b32 v33, 4, v0
    v_bfe_u32 v34, v0, 2, 2
    v_and_b32 v35, 3, v0
    v_lshrrev_b32 v36, 5, v0
    v_and_b32 v37, 15, v0
    v_lshl_add_u32 v38, v36, 3, v34
    v_mul_u32_u24 v38, 192, v38
    v_and_b32_e64 v39, 1, v33
    v_lshl_add_u32 v38, v39, 5, v38
    v_lshl_add_u32 v21, v35, 3, v38
    v_add_u32 v22, 43008, v21
    v_bfe_u32 v38, v0, 2, 3
    v_mul_u32_u24 v38, 3584, v38
    v_lshl_add_u32 v38, v36, 6, v38
    v_lshl_add_u32 v38, v35, 4, v38
    s_add_u32 s62, s84, 86016
    v_add_u32 v244, s62, v38
    v_mul_u32_u24 v38, 3584, v34
    v_lshl_add_u32 v38, v33, 6, v38
    v_lshl_add_u32 v38, v35, 4, v38
    s_and_b32 s63, s44, 1
    s_lshl_b32 s64, s44, 8
    s_add_u32 s62, s48, s64
    s_add_u32 s62, s62, 32768
    v_add_u32 v245, s62, v38
    v_lshl_add_u32 v38, v33, 3, v34
    v_mul_u32_u24 v38, 192, v38
    v_lshl_add_u32 v38, v35, 3, v38
    s_mul_i32 s62, s44, 6144
    v_add_u32 v246, s62, v38
    s_mul_i32 s62, s63, 6144
    s_add_u32 s62, s62, 73728
    v_add_u32 v247, s62, v38
    v_lshrrev_b32 v38, 3, v37
    v_lshlrev_b32 v38, 11, v38
    v_and_b32 v34, 7, v37
    v_lshl_add_u32 v38, v34, 4, v38
    v_lshl_add_u32 v38, v39, 9, v38
    v_lshl_add_u32 v38, v36, 3, v38
    s_lshl_b32 s62, s63, 10
    s_add_u32 s62, s62, 16768
    v_add_u32 v38, s62, v38
    v_lshlrev_b32 v34, 8, v33
    v_lshl_add_u32 v34, v37, 3, v34
    s_lshl_b32 s62, s63, 7
    s_add_u32 s62, s62, 158208
L_STUB0:
    s_cbranch_execz L_STUB4
    v_add_u32 v34, s62, v34
    s_cmp_lt_u32 s44, 2
    s_cselect_b64 vcc, -1, 0
    s_cselect_b32 s93, 0, 16777216
    v_cndmask_b32 v248, v34, v38, vcc
    v_min_u32 v38, 11, v37
    s_lshl_b32 s62, s44, 3
    v_add_u32 v34, s62, v38
    v_cmp_gt_u32 vcc, 8, v38
    v_add_u32 v38, 24, v38
    s_lshl_b32 s62, s42, 12
    s_add_u32 s62, s62, 524288
    v_cndmask_b32 v34, v38, v34, vcc
    v_lshl_add_u32 v34, v34, 2, s62
    v_cmp_gt_u32 vcc, 32, v0
    s_lshl_b32 s62, s42, 11
    s_add_u32 s62, s62, 229376
    v_lshl_add_u32 v38, v37, 7, s62
    v_cndmask_b32 v184, v38, v34, vcc
    v_cndmask_b32 v249, 0, -1, vcc
    s_lshr_b32 s62, s54, 1
    v_add_u32 v250, s62, v2
    s_lshr_b32 s62, s54, 3
    s_add_u32 s62, s62, 158208
    v_lshl_add_u32 v251, v0, 3, s62
    s_lshr_b32 s62, s54, 2
    v_add_u32 v253, s62, v2
    v_add_u32 v254, s54, v2
    v_mov_b32 v252, 0x3f803f80
    v_mov_b32 v230, 0
    v_mov_b32 v231, 0
    v_mov_b32 v242, 0
    v_mov_b32 v243, 0
    v_and_b32 v38, 31, v0
    v_lshlrev_b32 v34, 2, v36
    v_sub_u32 v38, v38, v34
    v_add_u32 v38, 5, v38
    s_mov_b64 s[62:63], 0xff
    v_lshlrev_b64 v[34:35], v38, s[62:63]
    v_not_b32 v34, v34
    v_not_b32 v35, v35
    s_lshr_b32 s62, s44, 1
    s_or_b32 s62, s62, s42
    s_cmp_eq_u32 s62, 0
    s_cselect_b32 s62, 0xf0, 0
    v_or_b32_e64 v34, s62, v34
    s_mov_b32 s62, 0xffff
    v_bfe_i32 v164, v34, 12, 1
    v_bfe_i32 v165, v34, 13, 1
    v_bitop3_b32 v232, s62, v164, v165 bitop3:0x35
    v_and_b32 v164, 0xf149f2ca, v164
    v_and_b32 v165, 0xf149f2ca, v165
    v_bfe_i32 v166, v34, 14, 1
    v_bfe_i32 v167, v34, 15, 1
    v_bitop3_b32 v233, s62, v166, v167 bitop3:0x35
    v_and_b32 v166, 0xf149f2ca, v166
    v_and_b32 v167, 0xf149f2ca, v167
    v_bfe_i32 v168, v34, 20, 1
    v_bfe_i32 v169, v34, 21, 1
    v_bitop3_b32 v234, s62, v168, v169 bitop3:0x35
    v_and_b32 v168, 0xf149f2ca, v168
    v_and_b32 v169, 0xf149f2ca, v169
    v_bfe_i32 v170, v34, 22, 1
    v_bfe_i32 v171, v34, 23, 1
    v_bitop3_b32 v235, s62, v170, v171 bitop3:0x35
    v_and_b32 v170, 0xf149f2ca, v170
    v_and_b32 v171, 0xf149f2ca, v171
    v_bfe_i32 v172, v34, 28, 1
    v_bfe_i32 v173, v34, 29, 1
    v_bitop3_b32 v236, s62, v172, v173 bitop3:0x35
    v_and_b32 v172, 0xf149f2ca, v172
    v_and_b32 v173, 0xf149f2ca, v173
    v_bfe_i32 v174, v34, 30, 1
    v_bfe_i32 v175, v34, 31, 1
    v_bitop3_b32 v237, s62, v174, v175 bitop3:0x35
    v_and_b32 v174, 0xf149f2ca, v174
    v_and_b32 v175, 0xf149f2ca, v175
    v_bfe_i32 v176, v35, 4, 1
    v_bfe_i32 v177, v35, 5, 1
    v_bitop3_b32 v238, s62, v176, v177 bitop3:0x35
    v_and_b32 v176, 0xf149f2ca, v176
    v_and_b32 v177, 0xf149f2ca, v177
    v_bfe_i32 v178, v35, 6, 1
    v_bfe_i32 v179, v35, 7, 1
    v_bitop3_b32 v239, s62, v178, v179 bitop3:0x35
    v_and_b32 v178, 0xf149f2ca, v178
    v_and_b32 v179, 0xf149f2ca, v179
    v_bfe_i32 v192, v34, 4, 1
    v_bfe_i32 v193, v34, 5, 1
    v_bitop3_b32 v240, s62, v192, v193 bitop3:0x35
    v_and_b32 v192, 0xf149f2ca, v192
    v_and_b32 v193, 0xf149f2ca, v193
    v_bfe_i32 v194, v34, 6, 1
    v_bfe_i32 v195, v34, 7, 1
    v_bitop3_b32 v241, s62, v194, v195 bitop3:0x35
    v_and_b32 v194, 0xf149f2ca, v194
    v_and_b32 v195, 0xf149f2ca, v195
    s_mov_b32 s62, 0xcba97531
    s_mov_b32 s63, 0x0086420d
    s_lshl_b32 s64, s43, 2
    s_lshr_b64 s[62:63], s[62:63], s64
    s_and_b32 s62, s62, 15
    s_sub_u32 s63, 13, s62
    s_cmp_lt_u32 s42, 8
    s_cselect_b32 s55, s62, s63
    s_and_b32 s51, s55, 1
    s_lshr_b32 s52, s55, 1
    s_sub_u32 s63, s2, 224
    s_min_u32 s63, s63, 27
    s_movk_i32 s60, 896
    s_mov_b32 s59, 0x20000
    s_cmp_lt_u32 s43, 14
    s_cselect_b64 s[56:57], s[12:13], s[16:17]
    s_cselect_b32 s58, s14, s18
    s_cselect_b32 s60, s60, 3584
    s_cselect_b32 s63, s52, s63
    s_lshl_b32 s63, s63, 7
    s_lshr_b32 s65, s42, 3
    s_lshl_b32 s64, s44, 1
    s_add_u32 s64, s64, s65
    s_mul_i32 s89, s64, 7168
    s_xor_b32 s62, s64, 1
    s_mul_i32 s61, s62, 7168
    s_mul_i32 s64, s64, 56
    s_mul_i32 s64, s64, s60
    s_add_u32 s87, s63, s64
    s_mul_i32 s65, s65, -112
    s_add_u32 s65, s65, 24
    s_mul_i32 s66, s65, s60
    s_mul_i32 s68, s65, 3584
    s_add_u32 m0, s88, s75
    s_add_u32 s71, s70, s75
    buffer_load_dwordx4 v2, s[32:35], s71 offen offset:0 sc1 lds
    buffer_load_dwordx4 v2, s[32:35], s71 offen offset:1024 sc1 lds
    buffer_load_dwordx4 v2, s[32:35], s71 offen offset:2048 sc1 lds
    buffer_load_dwordx4 v2, s[32:35], s71 offen offset:3072 sc1 lds
    s_add_u32 m0, s88, s76
    s_add_u32 s71, s70, s76
    buffer_load_dwordx4 v2, s[32:35], s71 offen offset:0 sc1 lds
    buffer_load_dwordx4 v2, s[32:35], s71 offen offset:1024 sc1 lds
    buffer_load_dwordx4 v2, s[32:35], s71 offen offset:2048 sc1 lds
    buffer_load_dwordx4 v2, s[32:35], s71 offen offset:3072 sc1 lds
    s_lshr_b32 s67, s42, 3
    s_mul_i32 s67, s67, 7
    s_add_u32 s67, s67, s43
    s_lshl_b32 s67, s67, 2
    s_add_u32 s67, s67, s44
    s_mul_i32 s67, s67, 3072
    s_add_u32 s67, s67, 11501568
    v_min_u32 v32, 23, v0
    v_lshlrev_b32 v32, 7, v32
    buffer_load_dword v26, v32, s[32:35], s67 offen sc1
    s_mov_b32 s73, 0xffffff00
    s_waitcnt vmcnt(10)
    s_barrier
    ds_read_b64_tr_b16 v[104:105], v140 offset:0
    ds_read_b64_tr_b16 v[106:107], v140 offset:1024
    ds_read_b64_tr_b16 v[108:109], v140 offset:4096
    ds_read_b64_tr_b16 v[110:111], v140 offset:5120
    ds_read_b64_tr_b16 v[112:113], v140 offset:8192
    ds_read_b64_tr_b16 v[114:115], v140 offset:9216
    ds_read_b64_tr_b16 v[116:117], v140 offset:12288
    ds_read_b64_tr_b16 v[118:119], v140 offset:13312
    s_waitcnt lgkmcnt(6)
    v_mfma_f32_16x16x32_bf16 v[136:139], v[120:123], v[104:107], 0
    s_waitcnt lgkmcnt(4)
    v_mfma_f32_16x16x32_bf16 v[136:139], v[124:127], v[108:111], v[136:139]
    s_waitcnt lgkmcnt(2)
    v_mfma_f32_16x16x32_bf16 v[136:139], v[128:131], v[112:115], v[136:139]
    s_waitcnt lgkmcnt(0)
    v_mfma_f32_16x16x32_bf16 v[136:139], v[132:135], v[116:119], v[136:139]
    s_nop 7
    v_lshlrev_b32 v137, 2, v0
    s_mov_b64 exec, 0xffff
    v_and_or_b32 v136, v136, s73, v144
    buffer_store_dword v136, v137, s[32:35], s72 offen offset:3584 sc1
    s_mov_b64 exec, -1
    s_add_u32 m0, s88, s77
    s_add_u32 s71, s70, s77
    buffer_load_dwordx4 v2, s[32:35], s71 offen offset:0 sc1 lds
    v_lshrrev_b32 v5, 3, v0
    v_mad_u32_u24 v4, v5, s60, v31
    s_lshl_b32 s62, s60, 3
    s_sub_u32 s62, s62, 1024
    v_add_u32 v5, s62, v4
    v_add_u32 v6, s62, v5
    v_add_u32 v7, s62, v6
    s_lshl_b32 s60, s60, 5
    v_lshrrev_b32 v29, 3, v0
    v_mul_u32_u24 v29, 1792, v29
    v_and_b32 v30, 7, v0
    v_lshl_add_u32 v28, v30, 4, v29
    s_lshl_b32 s62, s51, 1
    s_lshr_b32 s63, s44, 1
    s_add_u32 s62, s62, s63
    s_mul_i32 s85, s62, 114688
    s_add_u32 s85, s85, s48
    s_lshl_b32 s62, s42, 7
    s_lshl_b32 s64, s51, 6
    s_add_u32 s62, s62, s64
    s_add_u32 s62, s62, s63
    buffer_load_dwordx4 v2, s[32:35], s71 offen offset:1024 sc1 lds
    s_and_b32 s64, s44, 1
    s_lshl_b32 s64, s64, 5
    s_add_u32 s62, s62, s64
    s_mul_i32 s62, s62, 896
    s_lshl_b32 s64, s52, 7
    s_add_u32 s86, s62, s64
    v_lshl_add_u32 v20, v0, 1, s64
    v_lshrrev_b32 v29, 4, v0
    v_and_b32 v30, 15, v0
    v_lshlrev_b32 v30, 4, v30
    v_lshl_add_u32 v27, v29, 9, v30
    s_lshl_b32 s94, s45, 11
    s_add_u32 s94, s94, s84
    s_lshl_b32 s69, s42, 12
    s_add_u32 s69, s69, 524288
    s_lshl_b32 s63, s44, 7
    s_add_u32 s62, s69, s63
    s_lshl_b32 s63, s43, 2
    s_add_u32 s62, s62, s63
    s_add_u32 s95, s62, 256
    v_lshrrev_b32 v9, 3, v0
    buffer_load_dwordx4 v2, s[32:35], s71 offen offset:2048 sc1 lds
    v_mul_u32_u24 v8, 3584, v9
    v_add_u32 v8, v8, v31
    v_add_u32 v9, 27648, v8
    v_add_u32 v10, 55296, v8
    v_add_u32 v11, 82944, v8
    s_mul_i32 s62, s44, 1792
    s_lshl_b32 s63, s52, 8
    s_add_u32 s62, s62, s63
    v_lshl_add_u32 v31, v0, 2, s62
    v_lshlrev_b32 v29, 3, v0
    v_add_u32 v29, 143360, v29
    ds_write_b64 v29, v[230:231]
    s_and_b32 s62, s44, 1
    s_mul_i32 s62, s62, 3584
    s_lshl_b32 s63, s52, 9
    s_add_u32 s62, s62, s63
    s_add_u32 s62, s62, s85
    s_add_u32 s96, s62, 78848
    v_min_u32 v29, 19, v0
    v_cmp_gt_u32 vcc, 16, v0
    v_lshlrev_b32 v29, 7, v29
    v_add_u32 v185, s94, v29
    s_sub_u32 s62, s96, 2048
    v_add_u32 v29, s62, v29
    v_cndmask_b32 v185, v29, v185, vcc
    buffer_load_dwordx4 v2, s[32:35], s71 offen offset:3072 sc1 lds
    v_bfi_b32 v25, v249, v3, v24
    s_add_u32 m0, s88, s78
    s_add_u32 s71, s70, s78
    buffer_load_dwordx4 v2, s[32:35], s71 offen offset:0 sc1 lds
    buffer_load_dwordx4 v2, s[32:35], s71 offen offset:1024 sc1 lds
    buffer_load_dwordx4 v2, s[32:35], s71 offen offset:2048 sc1 lds
    buffer_load_dwordx4 v2, s[32:35], s71 offen offset:3072 sc1 lds
    s_add_u32 m0, s88, s79
    s_add_u32 s71, s70, s79
    buffer_load_dwordx4 v2, s[32:35], s71 offen offset:0 sc1 lds
    buffer_load_dwordx4 v2, s[32:35], s71 offen offset:1024 sc1 lds
    buffer_load_dwordx4 v2, s[32:35], s71 offen offset:2048 sc1 lds
    buffer_load_dwordx4 v2, s[32:35], s71 offen offset:3072 sc1 lds
    s_add_u32 m0, s88, 20480
    s_add_u32 s71, s70, 20480
    buffer_load_dwordx4 v2, s[32:35], s71 offen offset:0 sc1 lds
    s_mov_b64 exec, 0
    s_cmp_eq_u32 s44, 0
    s_cbranch_scc1 L_STUB0
    s_cmp_eq_u32 s44, 1
    s_cbranch_scc1 L_STUB1
    s_cmp_eq_u32 s44, 2
    s_cbranch_scc1 L_STUB2
    s_branch L_STUB3
L_BACK:
    s_cmp_lt_u32 s43, 9
    s_cbranch_scc1 L_BACKP
    s_mov_b64 exec, -1
RA_7:
L_STUB1:
    s_cbranch_execz L_STUB5
    s_waitcnt vmcnt(13)
    v_add_u32 v208, s75, v19
    ds_read_b64 v[196:197], v208
    v_add_u32 v208, s76, v19
    ds_read_b64 v[198:199], v208
    s_waitcnt lgkmcnt(0)
    v_bitop3_b32 v196, v197, v199, s40 bitop3:0x7e
    v_cmp_eq_u32 vcc, 0, v196
    s_nop 0
    s_cmp_eq_u64 vcc, -1
    s_cbranch_scc0 WV_9
WR_10:
    s_waitcnt vmcnt(9)
    v_add_u32 v208, s77, v19
    ds_read_b64 v[200:201], v208
    s_waitcnt vmcnt(5)
    v_add_u32 v208, s78, v19
    ds_read_b64 v[202:203], v208
    buffer_load_dword v24, v184, s[32:35], 0 offen sc1
    s_waitcnt vmcnt(1)
    v_add_u32 v208, s79, v19
    ds_read_b64 v[204:205], v208
    ds_read_b64 v[206:207], v19 offset:17408
    s_waitcnt lgkmcnt(0)
    v_bitop3_b32 v196, v197, v199, s40 bitop3:0x7e
    v_bitop3_b32 v200, v201, v203, s40 bitop3:0x7e
    v_bitop3_b32 v204, v205, v207, s40 bitop3:0x7e
    v_or3_b32 v196, v196, v200, v204
    v_cmp_eq_u32 vcc, 0, v196
    s_nop 0
    s_cmp_eq_u64 vcc, -1
    s_cbranch_scc0 WV_11
WR_12:
    s_barrier
    ds_read_b64_tr_b16 v[96:97], v21 offset:0
    ds_read_b64_tr_b16 v[98:99], v21 offset:768
    ds_read_b64_tr_b16 v[100:101], v21 offset:64
    ds_read_b64_tr_b16 v[102:103], v21 offset:832
    ds_read_b64_tr_b16 v[104:105], v21 offset:128
    ds_read_b64_tr_b16 v[106:107], v21 offset:896
    ds_read_b64_tr_b16 v[108:109], v21 offset:3072
    ds_read_b64_tr_b16 v[110:111], v21 offset:3840
    ds_read_b64_tr_b16 v[112:113], v21 offset:3136
    ds_read_b64_tr_b16 v[114:115], v21 offset:3904
    ds_read_b64_tr_b16 v[116:117], v21 offset:3200
    ds_read_b64_tr_b16 v[118:119], v21 offset:3968
    s_mov_b32 s53, 40000
    s_mov_b32 s47, -1
    s_branch PL_13
PA_15:
    v_xor_b32 v24, s46, v24
    v_cmp_gt_u32 s[62:63], 8, v24
    s_nop 0
    s_andn2_b32 s63, s63, vcc_hi
    s_cbranch_scc1 HS_17
    v_mov_b32 v24, v25
    s_andn2_b32 exec_hi, -1, vcc_hi
    buffer_load_dword v24, v184, s[32:35], 0 offen sc1
    s_mov_b32 exec_hi, -1
    s_sub_u32 s53, s53, 1
    s_cbranch_scc1 L_END
PL_13:
    s_waitcnt vmcnt(0)
    v_cmp_eq_u32 vcc, v24, v25
    s_nop 0
    s_cmp_eq_u64 vcc, -1
    s_cbranch_scc0 PA_15
PD_14:
    buffer_load_dwordx4 a[0:3], v244, s[32:35], 0 offen offset:0 sc1
    buffer_load_dwordx4 a[4:7], v244, s[32:35], 0 offen offset:128 sc1
    v_add_u32 v157, 86016, v12
    v_add_u32 v158, 86016, v13
    v_add_u32 v159, 86016, v14
    v_add_u32 v160, 86016, v15
    s_mul_i32 s62, s89, 28
    s_lshl_b32 s63, s55, 8
    s_add_u32 s9, s62, s63
    s_add_u32 s8, s9, 128
    s_cmp_lt_u32 s43, 14
    s_cselect_b32 s8, s8, 16777216
    v_lshrrev_b32 v25, 4, v0
    v_and_b32 v29, 15, v0
    buffer_load_dwordx4 a[8:11], v244, s[32:35], 0 offen offset:256 sc1
    s_lshl_b32 s63, s51, 1
    s_lshr_b32 s64, s44, 1
    s_add_u32 s63, s63, s64
    s_lshl_b32 s63, s63, 7
    s_add_u32 s63, s63, s69
    s_add_u32 s64, s63, 256
    v_lshl_add_u32 v23, v29, 2, s64
    s_and_b32 s65, s44, 1
    s_mul_i32 s64, s65, 7
    s_add_u32 s64, s64, s52
    s_lshl_b32 s64, s64, 2
    buffer_load_dwordx4 a[12:15], v244, s[32:35], 0 offen offset:384 sc1
    s_add_u32 s13, s63, s64
    s_lshl_b32 s63, s65, 8
    s_add_u32 s10, s85, s63
    s_mul_i32 s63, s65, 14336
    s_add_u32 s11, s85, s63
    s_lshl_b32 s63, s52, 11
    s_add_u32 s11, s11, s63
    s_add_u32 s11, s11, 86016
    v_lshlrev_b32 v161, 7, v29
    v_lshl_add_u32 v161, v25, 3, v161
    s_lshr_b32 s63, s54, 1
    buffer_load_dwordx4 a[16:19], v244, s[32:35], 0 offen offset:512 sc1
    s_add_u32 s63, s63, 145920
    v_add_u32 v161, s63, v161
    v_lshlrev_b32 v162, 4, v25
    s_mov_b32 s62, 0x22222412
    s_mov_b32 s63, 0x11111111
    v_lshlrev_b32 v25, 2, v29
    v_lshrrev_b64 v[148:149], v25, s[62:63]
    v_and_b32 v148, 7, v148
    v_lshl_add_u32 v163, v148, 7, v162
    v_add_u32 v163, 145152, v163
    v_add_u32 v162, 143872, v162
    buffer_load_dwordx4 a[20:23], v244, s[32:35], 0 offen offset:640 sc1
    s_waitcnt vmcnt(5) lgkmcnt(6)
    v_mfma_f32_32x32x16_bf16 v[48:63], v[100:103], a[0:3], 0
    ds_read_b64_tr_b16 v[120:121], v21 offset:6144
    ds_read_b64_tr_b16 v[122:123], v21 offset:6912
    buffer_load_dwordx4 a[112:115], v245, s[32:35], 0 offen offset:0 sc1
    v_mfma_f32_32x32x16_bf16 v[32:47], v[96:99], a[0:3], 0
    ds_read_b64_tr_b16 v[124:125], v21 offset:6208
    ds_read_b64_tr_b16 v[126:127], v21 offset:6976
    buffer_load_dwordx4 a[24:27], v244, s[32:35], 0 offen offset:768 sc1
    v_mfma_f32_32x32x16_bf16 v[64:79], a[0:3], v[104:107], 0
    ds_read_b64_tr_b16 v[128:129], v21 offset:6272
    ds_read_b64_tr_b16 v[130:131], v21 offset:7040
    v_lshrrev_b32 v25, 5, v0
    v_lshlrev_b32 v25, 8, v25
    s_waitcnt vmcnt(6) lgkmcnt(6)
    v_mfma_f32_32x32x16_bf16 v[48:63], v[112:115], a[4:7], v[48:63]
    ds_read_b64_tr_b16 v[96:97], v21 offset:9216
    ds_read_b64_tr_b16 v[98:99], v21 offset:9984
    buffer_load_dwordx4 a[28:31], v244, s[32:35], 0 offen offset:896 sc1
    v_mfma_f32_32x32x16_bf16 v[32:47], v[108:111], a[4:7], v[32:47]
    ds_read_b64_tr_b16 v[100:101], v21 offset:9280
    ds_read_b64_tr_b16 v[102:103], v21 offset:10048
    v_lshl_add_u32 v30, v29, 4, v25
    s_add_u32 s14, s84, 86016
    s_add_u32 s15, s84, 78848
    v_mfma_f32_32x32x16_bf16 v[64:79], a[4:7], v[116:119], v[64:79]
    ds_read_b64_tr_b16 v[104:105], v21 offset:9344
    ds_read_b64_tr_b16 v[106:107], v21 offset:10112
    s_lshl_b32 s62, s55, 12
    s_add_u32 s24, s62, 131072
    s_waitcnt vmcnt(6) lgkmcnt(6)
    v_mfma_f32_32x32x16_bf16 v[48:63], v[124:127], a[8:11], v[48:63]
    ds_read_b64_tr_b16 v[108:109], v21 offset:12288
    ds_read_b64_tr_b16 v[110:111], v21 offset:13056
    buffer_load_dwordx4 a[32:35], v244, s[32:35], 0 offen offset:1024 sc1
    v_mfma_f32_32x32x16_bf16 v[32:47], v[120:123], a[8:11], v[32:47]
    ds_read_b64_tr_b16 v[112:113], v21 offset:12352
    ds_read_b64_tr_b16 v[114:115], v21 offset:13120
    buffer_load_dwordx4 a[116:119], v245, s[32:35], 0 offen offset:1024 sc1
    v_mfma_f32_32x32x16_bf16 v[64:79], a[8:11], v[128:131], v[64:79]
    ds_read_b64_tr_b16 v[116:117], v21 offset:12416
    ds_read_b64_tr_b16 v[118:119], v21 offset:13184
    s_lshl_b32 s62, s55, 11
    s_add_u32 s25, s62, s84
    s_waitcnt vmcnt(7) lgkmcnt(6)
    v_mfma_f32_32x32x16_bf16 v[48:63], v[100:103], a[12:15], v[48:63]
    ds_read_b64_tr_b16 v[132:133], v246 offset:64
    ds_read_b64_tr_b16 v[134:135], v246 offset:832
    ds_read_b64_tr_b16 v[136:137], v246 offset:96
    ds_read_b64_tr_b16 v[138:139], v246 offset:864
    buffer_load_dwordx4 a[36:39], v244, s[32:35], 0 offen offset:1152 sc1
    v_mfma_f32_32x32x16_bf16 v[32:47], v[96:99], a[12:15], v[32:47]
    ds_read_b64_tr_b16 v[120:121], v21 offset:15360
    ds_read_b64_tr_b16 v[122:123], v21 offset:16128
    ds_read_b64_tr_b16 v[124:125], v21 offset:15424
    ds_read_b64_tr_b16 v[126:127], v21 offset:16192
    s_lshl_b32 s62, s44, 6
    v_mfma_f32_32x32x16_bf16 v[64:79], a[12:15], v[104:107], v[64:79]
    ds_read_b64_tr_b16 v[128:129], v21 offset:15488
    ds_read_b64_tr_b16 v[130:131], v21 offset:16256
    s_lshl_b32 s63, s55, 2
    s_add_u32 s62, s62, s63
    s_waitcnt vmcnt(5) lgkmcnt(6)
    v_mfma_f32_32x32x16_bf16 v[48:63], v[112:115], a[16:19], v[48:63]
    ds_read_b64_tr_b16 v[96:97], v21 offset:18432
    ds_read_b64_tr_b16 v[98:99], v21 offset:19200
    buffer_load_dwordx4 a[40:43], v244, s[32:35], 0 offen offset:1280 sc1
    v_mfma_f32_32x32x16_bf16 v[32:47], v[108:111], a[16:19], v[32:47]
    ds_read_b64_tr_b16 v[100:101], v21 offset:18496
    ds_read_b64_tr_b16 v[102:103], v21 offset:19264
    buffer_load_dwordx4 a[44:47], v244, s[32:35], 0 offen offset:1408 sc1
    v_mfma_f32_16x16x32_bf16 v[80:83], v[132:135], a[112:115], 0
    ds_read_b64_tr_b16 v[104:105], v21 offset:18560
    v_mfma_f32_32x32x16_bf16 v[64:79], a[16:19], v[116:119], v[64:79]
    ds_read_b64_tr_b16 v[106:107], v21 offset:19328
    s_add_u32 s62, s62, s69
    s_add_u32 s27, s62, 1280
    s_lshl_b32 s63, s44, 6
    v_mfma_f32_16x16x32_bf16 v[84:87], v[136:139], a[112:115], 0
    s_waitcnt lgkmcnt(6)
    v_mfma_f32_32x32x16_bf16 v[48:63], v[124:127], a[20:23], v[48:63]
    ds_read_b64_tr_b16 v[140:141], v246 offset:128
    ds_read_b64_tr_b16 v[142:143], v246 offset:896
    ds_read_b64_tr_b16 v[144:145], v246 offset:160
    ds_read_b64_tr_b16 v[146:147], v246 offset:928
    buffer_load_dwordx4 a[120:123], v245, s[32:35], 0 offen offset:2048 sc1
    v_mfma_f32_32x32x16_bf16 v[32:47], v[120:123], a[20:23], v[32:47]
    ds_read_b64_tr_b16 v[108:109], v21 offset:21504
    ds_read_b64_tr_b16 v[110:111], v21 offset:22272
    ds_read_b64_tr_b16 v[112:113], v21 offset:21568
    ds_read_b64_tr_b16 v[114:115], v21 offset:22336
    s_add_u32 s26, s62, s63
    v_mfma_f32_32x32x16_bf16 v[64:79], a[20:23], v[128:131], v[64:79]
    ds_read_b64_tr_b16 v[116:117], v21 offset:21632
    ds_read_b64_tr_b16 v[118:119], v21 offset:22400
    s_andn2_b32 s90, s26, 127
    s_lshr_b32 s63, s44, 1
    s_waitcnt vmcnt(7) lgkmcnt(6)
    v_mfma_f32_32x32x16_bf16 v[48:63], v[100:103], a[24:27], v[48:63]
    ds_read_b64_tr_b16 v[120:121], v21 offset:24576
    ds_read_b64_tr_b16 v[122:123], v21 offset:25344
    buffer_load_dwordx4 a[48:51], v244, s[32:35], 0 offen offset:1536 sc1
    v_mfma_f32_32x32x16_bf16 v[32:47], v[96:99], a[24:27], v[32:47]
    ds_read_b64_tr_b16 v[124:125], v21 offset:24640
    ds_read_b64_tr_b16 v[126:127], v21 offset:25408
    buffer_load_dwordx4 a[52:55], v244, s[32:35], 0 offen offset:1664 sc1
    v_mfma_f32_16x16x32_bf16 v[88:91], a[112:115], v[140:143], 0
    ds_read_b64_tr_b16 v[128:129], v21 offset:24704
    v_mfma_f32_32x32x16_bf16 v[64:79], a[24:27], v[104:107], v[64:79]
    ds_read_b64_tr_b16 v[130:131], v21 offset:25472
    s_lshl_b32 s62, s63, 6
    s_add_u32 s91, s69, s62
    s_lshl_b32 s63, s63, 1
    v_mfma_f32_16x16x32_bf16 v[92:95], a[112:115], v[144:147], 0
    s_waitcnt vmcnt(8) lgkmcnt(6)
    v_mfma_f32_32x32x16_bf16 v[48:63], v[112:115], a[28:31], v[48:63]
    ds_read_b64_tr_b16 v[132:133], v246 offset:24640
    ds_read_b64_tr_b16 v[134:135], v246 offset:25408
    ds_read_b64_tr_b16 v[136:137], v246 offset:24672
    ds_read_b64_tr_b16 v[138:139], v246 offset:25440
    buffer_load_dwordx4 a[56:59], v244, s[32:35], 0 offen offset:1792 sc1
    v_mfma_f32_32x32x16_bf16 v[32:47], v[108:111], a[28:31], v[32:47]
    ds_read_b64_tr_b16 v[96:97], v21 offset:27648
    ds_read_b64_tr_b16 v[98:99], v21 offset:28416
    ds_read_b64_tr_b16 v[100:101], v21 offset:27712
    ds_read_b64_tr_b16 v[102:103], v21 offset:28480
    s_add_u32 s63, s63, s51
    v_mfma_f32_32x32x16_bf16 v[64:79], a[28:31], v[116:119], v[64:79]
    ds_read_b64_tr_b16 v[104:105], v21 offset:27776
    ds_read_b64_tr_b16 v[106:107], v21 offset:28544
    s_lshl_b32 s63, s63, 1
    s_add_u32 s63, s63, s65
    s_waitcnt vmcnt(7) lgkmcnt(6)
    v_mfma_f32_32x32x16_bf16 v[48:63], v[124:127], a[32:35], v[48:63]
    ds_read_b64_tr_b16 v[140:141], v246 offset:24704
    ds_read_b64_tr_b16 v[142:143], v246 offset:25472
    ds_read_b64_tr_b16 v[144:145], v246 offset:24736
    buffer_load_dwordx4 a[124:127], v245, s[32:35], s93 offen offset:3072 sc1
    v_mfma_f32_32x32x16_bf16 v[32:47], v[120:123], a[32:35], v[32:47]
    ds_read_b64_tr_b16 v[146:147], v246 offset:25504
    ds_read_b64_tr_b16 v[108:109], v21 offset:30720
    ds_read_b64_tr_b16 v[110:111], v21 offset:31488
    buffer_load_dwordx4 a[60:63], v244, s[32:35], 0 offen offset:1920 sc1
    v_mfma_f32_16x16x32_bf16 v[80:83], v[132:135], a[116:119], v[80:83]
    ds_read_b64_tr_b16 v[112:113], v21 offset:30784
    v_mfma_f32_32x32x16_bf16 v[64:79], a[32:35], v[128:131], v[64:79]
    ds_read_b64_tr_b16 v[114:115], v21 offset:31552
    ds_read_b64_tr_b16 v[116:117], v21 offset:30848
    ds_read_b64_tr_b16 v[118:119], v21 offset:31616
    s_mul_i32 s77, s63, 28672
    v_mfma_f32_16x16x32_bf16 v[84:87], v[136:139], a[116:119], v[84:87]
    s_waitcnt vmcnt(8) lgkmcnt(6)
    v_mfma_f32_32x32x16_bf16 v[48:63], v[100:103], a[36:39], v[48:63]
    ds_read_b64_tr_b16 v[120:121], v21 offset:33792
    ds_read_b64_tr_b16 v[122:123], v21 offset:34560
    buffer_load_dwordx4 a[64:67], v244, s[32:35], 0 offen offset:2048 sc1
    v_mfma_f32_32x32x16_bf16 v[32:47], v[96:99], a[36:39], v[32:47]
    ds_read_b64_tr_b16 v[124:125], v21 offset:33856
    ds_read_b64_tr_b16 v[126:127], v21 offset:34624
    s_lshl_b32 s62, s52, 7
    s_add_u32 s77, s77, s62
    s_and_b32 s64, s2, 7
    v_mfma_f32_16x16x32_bf16 v[88:91], a[116:119], v[140:143], v[88:91]
    ds_read_b64_tr_b16 v[128:129], v21 offset:33920
    v_mfma_f32_32x32x16_bf16 v[64:79], a[36:39], v[104:107], v[64:79]
    ds_read_b64_tr_b16 v[130:131], v21 offset:34688
    s_lshr_b32 s65, s42, 3
    s_mul_i32 s64, s64, 3
    s_mov_b32 s62, 0xd11ac688
    v_mfma_f32_16x16x32_bf16 v[92:95], a[116:119], v[144:147], v[92:95]
    s_waitcnt vmcnt(8) lgkmcnt(6)
    v_mfma_f32_32x32x16_bf16 v[48:63], v[112:115], a[40:43], v[48:63]
    ds_read_b64_tr_b16 v[132:133], v246 offset:49216
    ds_read_b64_tr_b16 v[134:135], v246 offset:49984
    ds_read_b64_tr_b16 v[136:137], v246 offset:49248
    ds_read_b64_tr_b16 v[138:139], v246 offset:50016
    buffer_load_dwordx4 a[68:71], v244, s[32:35], 0 offen offset:2176 sc1
    v_mfma_f32_32x32x16_bf16 v[32:47], v[108:111], a[40:43], v[32:47]
    ds_read_b64_tr_b16 v[96:97], v21 offset:36864
    ds_read_b64_tr_b16 v[98:99], v21 offset:37632
    ds_read_b64_tr_b16 v[100:101], v21 offset:36928
    ds_read_b64_tr_b16 v[102:103], v21 offset:37696
    buffer_load_dwordx4 a[72:75], v244, s[32:35], 0 offen offset:2304 sc1
    v_mfma_f32_32x32x16_bf16 v[64:79], a[40:43], v[116:119], v[64:79]
    ds_read_b64_tr_b16 v[104:105], v21 offset:36992
    ds_read_b64_tr_b16 v[106:107], v21 offset:37760
    s_mov_b32 s63, 0x6b1a2358
    s_lshr_b64 s[62:63], s[62:63], s64
    s_waitcnt vmcnt(8) lgkmcnt(6)
    v_mfma_f32_32x32x16_bf16 v[48:63], v[124:127], a[44:47], v[48:63]
    ds_read_b64_tr_b16 v[140:141], v246 offset:49280
    ds_read_b64_tr_b16 v[142:143], v246 offset:50048
    ds_read_b64_tr_b16 v[144:145], v246 offset:49312
    buffer_load_dwordx4 a[76:79], v244, s[32:35], 0 offen offset:2432 sc1
    v_mfma_f32_32x32x16_bf16 v[32:47], v[120:123], a[44:47], v[32:47]
    ds_read_b64_tr_b16 v[146:147], v246 offset:50080
    ds_read_b64_tr_b16 v[108:109], v21 offset:39936
    ds_read_b64_tr_b16 v[110:111], v21 offset:40704
    s_mul_i32 s64, s65, 6
    s_add_u32 s64, s64, 196617
    v_mfma_f32_16x16x32_bf16 v[80:83], v[132:135], a[120:123], v[80:83]
    ds_read_b64_tr_b16 v[112:113], v21 offset:40000
    v_mfma_f32_32x32x16_bf16 v[64:79], a[44:47], v[128:131], v[64:79]
    ds_read_b64_tr_b16 v[114:115], v21 offset:40768
    ds_read_b64_tr_b16 v[116:117], v21 offset:40064
    ds_read_b64_tr_b16 v[118:119], v21 offset:40832
    s_bfe_u32 s64, s62, s64
    v_mfma_f32_16x16x32_bf16 v[84:87], v[136:139], a[120:123], v[84:87]
    s_waitcnt vmcnt(8) lgkmcnt(6)
    v_mfma_f32_32x32x16_bf16 v[48:63], v[100:103], a[48:51], v[48:63]
    ds_read_b64_tr_b16 v[120:121], v22 offset:0
    ds_read_b64_tr_b16 v[122:123], v22 offset:768
    buffer_load_dwordx4 a[80:83], v244, s[32:35], 0 offen offset:2560 sc1
    v_mfma_f32_32x32x16_bf16 v[32:47], v[96:99], a[48:51], v[32:47]
    ds_read_b64_tr_b16 v[124:125], v22 offset:64
    ds_read_b64_tr_b16 v[126:127], v22 offset:832
    buffer_load_dwordx4 a[84:87], v244, s[32:35], 0 offen offset:2688 sc1
    v_mfma_f32_16x16x32_bf16 v[88:91], a[120:123], v[140:143], v[88:91]
    ds_read_b64_tr_b16 v[128:129], v22 offset:128
    v_mfma_f32_32x32x16_bf16 v[64:79], a[48:51], v[104:107], v[64:79]
    ds_read_b64_tr_b16 v[130:131], v22 offset:896
    s_lshl_b32 s70, s64, 12
    s_mul_i32 s64, s65, 6
    s_add_u32 s64, s64, 196620
    v_mfma_f32_16x16x32_bf16 v[92:95], a[120:123], v[144:147], v[92:95]
    s_waitcnt vmcnt(9) lgkmcnt(6)
    v_mfma_f32_32x32x16_bf16 v[48:63], v[112:115], a[52:55], v[48:63]
    ds_read_b64_tr_b16 v[132:133], v247 offset:64
    ds_read_b64_tr_b16 v[134:135], v247 offset:832
    ds_read_b64_tr_b16 v[136:137], v247 offset:96
    ds_read_b64_tr_b16 v[138:139], v247 offset:864
    buffer_load_dwordx4 a[88:91], v244, s[32:35], 0 offen offset:2816 sc1
    v_mfma_f32_32x32x16_bf16 v[32:47], v[108:111], a[52:55], v[32:47]
    ds_read_b64_tr_b16 v[96:97], v22 offset:3072
    ds_read_b64_tr_b16 v[98:99], v22 offset:3840
    ds_read_b64_tr_b16 v[100:101], v22 offset:3136
    ds_read_b64_tr_b16 v[102:103], v22 offset:3904
    s_bfe_u32 s64, s62, s64
    v_mfma_f32_32x32x16_bf16 v[64:79], a[52:55], v[116:119], v[64:79]
    ds_read_b64_tr_b16 v[104:105], v22 offset:3200
    ds_read_b64_tr_b16 v[106:107], v22 offset:3968
    s_lshl_b32 s71, s64, 12
    s_bfe_u32 s64, s62, 196608
    s_waitcnt vmcnt(8) lgkmcnt(6)
L_STUB2:
    s_cbranch_execz L_STUB6
    v_mfma_f32_32x32x16_bf16 v[48:63], v[124:127], a[56:59], v[48:63]
    ds_read_b64_tr_b16 v[140:141], v247 offset:128
    ds_read_b64_tr_b16 v[142:143], v247 offset:896
    ds_read_b64_tr_b16 v[144:145], v247 offset:160
    buffer_load_dwordx4 a[92:95], v244, s[32:35], 0 offen offset:2944 sc1
    v_mfma_f32_32x32x16_bf16 v[32:47], v[120:123], a[56:59], v[32:47]
    ds_read_b64_tr_b16 v[146:147], v247 offset:928
    ds_read_b64_tr_b16 v[108:109], v22 offset:6144
    ds_read_b64_tr_b16 v[110:111], v22 offset:6912
    buffer_load_dwordx4 a[96:99], v244, s[32:35], 0 offen offset:3072 sc1
    v_mfma_f32_16x16x32_bf16 v[80:83], v[132:135], a[124:127], v[80:83]
    ds_read_b64_tr_b16 v[112:113], v22 offset:6208
    v_mfma_f32_32x32x16_bf16 v[64:79], a[56:59], v[128:131], v[64:79]
    ds_read_b64_tr_b16 v[114:115], v22 offset:6976
    ds_read_b64_tr_b16 v[116:117], v22 offset:6272
    ds_read_b64_tr_b16 v[118:119], v22 offset:7040
    s_lshl_b32 s72, s64, 12
    v_mfma_f32_16x16x32_bf16 v[84:87], v[136:139], a[124:127], v[84:87]
    s_waitcnt vmcnt(9) lgkmcnt(6)
    v_mfma_f32_32x32x16_bf16 v[48:63], v[100:103], a[60:63], v[48:63]
    ds_read_b64_tr_b16 v[120:121], v22 offset:9216
    ds_read_b64_tr_b16 v[122:123], v22 offset:9984
    buffer_load_dwordx4 a[100:103], v244, s[32:35], 0 offen offset:3200 sc1
    v_mfma_f32_32x32x16_bf16 v[32:47], v[96:99], a[60:63], v[32:47]
    ds_read_b64_tr_b16 v[124:125], v22 offset:9280
    ds_read_b64_tr_b16 v[126:127], v22 offset:10048
    s_bfe_u32 s64, s62, 196611
    s_lshl_b32 s73, s64, 12
    s_bfe_u32 s64, s62, 196614
    v_mfma_f32_16x16x32_bf16 v[88:91], a[124:127], v[140:143], v[88:91]
    ds_read_b64_tr_b16 v[128:129], v22 offset:9344
    v_mfma_f32_32x32x16_bf16 v[64:79], a[60:63], v[104:107], v[64:79]
    ds_read_b64_tr_b16 v[130:131], v22 offset:10112
    s_lshl_b32 s74, s64, 12
    s_mul_i32 s64, s65, -6
    s_add_u32 s64, s64, 196623
    v_mfma_f32_16x16x32_bf16 v[92:95], a[124:127], v[144:147], v[92:95]
    s_barrier
    s_waitcnt vmcnt(9) lgkmcnt(6)
    v_mfma_f32_32x32x16_bf16 v[48:63], v[112:115], a[64:67], v[48:63]
    ds_read_b64_tr_b16 v[96:97], v22 offset:12288
    ds_read_b64_tr_b16 v[98:99], v22 offset:13056
    buffer_load_dwordx4 a[104:107], v244, s[32:35], 0 offen offset:3328 sc1
    v_mfma_f32_32x32x16_bf16 v[32:47], v[108:111], a[64:67], v[32:47]
    ds_read_b64_tr_b16 v[100:101], v22 offset:12352
    ds_read_b64_tr_b16 v[102:103], v22 offset:13120
    buffer_load_dwordx4 a[108:111], v244, s[32:35], 0 offen offset:3456 sc1
    v_mfma_f32_32x32x16_bf16 v[64:79], a[64:67], v[116:119], v[64:79]
    ds_read_b64_tr_b16 v[104:105], v22 offset:12416
    ds_read_b64_tr_b16 v[106:107], v22 offset:13184
    ds_write_b128 v253, v[80:83] offset:0
    s_waitcnt vmcnt(10) lgkmcnt(7)
    v_mfma_f32_32x32x16_bf16 v[48:63], v[124:127], a[68:71], v[48:63]
    ds_read_b64_tr_b16 v[108:109], v22 offset:15360
    ds_read_b64_tr_b16 v[110:111], v22 offset:16128
    s_add_u32 m0, s89, 86016
    s_nop 0
    buffer_load_dwordx4 v4, s[56:59], s87 offen offset:0 lds
    v_mfma_f32_32x32x16_bf16 v[32:47], v[120:123], a[68:71], v[32:47]
    ds_read_b64_tr_b16 v[112:113], v22 offset:15424
    ds_read_b64_tr_b16 v[114:115], v22 offset:16192
    ds_write_b128 v253, v[84:87] offset:4096
    v_mfma_f32_32x32x16_bf16 v[64:79], a[68:71], v[128:131], v[64:79]
    ds_read_b64_tr_b16 v[116:117], v22 offset:15488
    ds_read_b64_tr_b16 v[118:119], v22 offset:16256
    ds_write_b128 v253, v[88:91] offset:8192
    s_waitcnt vmcnt(10) lgkmcnt(9)
    v_mfma_f32_32x32x16_bf16 v[48:63], v[100:103], a[72:75], v[48:63]
    ds_read_b64_tr_b16 v[120:121], v22 offset:18432
    ds_read_b64_tr_b16 v[122:123], v22 offset:19200
    buffer_load_dwordx4 v5, s[56:59], s87 offen offset:1024 lds
    v_mfma_f32_32x32x16_bf16 v[32:47], v[96:99], a[72:75], v[32:47]
    ds_read_b64_tr_b16 v[124:125], v22 offset:18496
    ds_read_b64_tr_b16 v[126:127], v22 offset:19264
    buffer_load_dwordx4 v6, s[56:59], s87 offen offset:2048 lds
    v_mfma_f32_32x32x16_bf16 v[64:79], a[72:75], v[104:107], v[64:79]
    ds_read_b64_tr_b16 v[128:129], v22 offset:18560
    ds_read_b64_tr_b16 v[130:131], v22 offset:19328
    ds_write_b128 v253, v[92:95] offset:12288
    s_waitcnt vmcnt(11) lgkmcnt(8)
    v_mfma_f32_32x32x16_bf16 v[48:63], v[112:115], a[76:79], v[48:63]
    ds_read_b64_tr_b16 v[96:97], v22 offset:21504
    ds_read_b64_tr_b16 v[98:99], v22 offset:22272
    buffer_load_dwordx4 v7, s[56:59], s87 offen offset:3072 lds
    v_mfma_f32_32x32x16_bf16 v[32:47], v[108:111], a[76:79], v[32:47]
    ds_read_b64_tr_b16 v[100:101], v22 offset:21568
    ds_read_b64_tr_b16 v[102:103], v22 offset:22336
    s_waitcnt lgkmcnt(4)
    s_barrier
    v_mfma_f32_32x32x16_bf16 v[64:79], a[76:79], v[116:119], v[64:79]
    ds_read_b64_tr_b16 v[104:105], v22 offset:21632
    ds_read_b64_tr_b16 v[106:107], v22 offset:22400
    ds_read_b128 v[80:83], v254 offset:0
    ds_read_b128 v[84:87], v254 offset:1024
    s_waitcnt vmcnt(11)
    v_mfma_f32_32x32x16_bf16 v[48:63], v[124:127], a[80:83], v[48:63]
    ds_read_b64_tr_b16 v[108:109], v22 offset:24576
    ds_read_b64_tr_b16 v[110:111], v22 offset:25344
    s_add_u32 m0, s89, 90112
    s_add_u32 s87, s87, s60
    buffer_load_dwordx4 v4, s[56:59], s87 offen offset:0 lds
    v_mfma_f32_32x32x16_bf16 v[32:47], v[120:123], a[80:83], v[32:47]
    ds_read_b64_tr_b16 v[112:113], v22 offset:24640
    ds_read_b64_tr_b16 v[114:115], v22 offset:25408
    buffer_load_dwordx4 v5, s[56:59], s87 offen offset:1024 lds
    v_mfma_f32_32x32x16_bf16 v[64:79], a[80:83], v[128:131], v[64:79]
    ds_read_b64_tr_b16 v[116:117], v22 offset:24704
    ds_read_b64_tr_b16 v[118:119], v22 offset:25472
    ds_read_b128 v[88:91], v254 offset:2048
    ds_read_b128 v[92:95], v254 offset:3072
    s_waitcnt vmcnt(12) lgkmcnt(10)
    v_mfma_f32_32x32x16_bf16 v[48:63], v[100:103], a[84:87], v[48:63]
    ds_read_b64_tr_b16 v[120:121], v22 offset:27648
    ds_read_b64_tr_b16 v[122:123], v22 offset:28416
    buffer_load_dwordx4 v6, s[56:59], s87 offen offset:2048 lds
    v_mfma_f32_32x32x16_bf16 v[32:47], v[96:99], a[84:87], v[32:47]
    ds_read_b64_tr_b16 v[124:125], v22 offset:27712
    ds_read_b64_tr_b16 v[126:127], v22 offset:28480
    s_waitcnt lgkmcnt(4)
    v_mfma_f32_32x32x16_bf16 v[64:79], a[84:87], v[104:107], v[64:79]
    ds_read_b64_tr_b16 v[128:129], v22 offset:27776
    ds_read_b64_tr_b16 v[130:131], v22 offset:28544
    v_add_f32 v80, v80, v88
    v_add_f32 v81, v81, v89
    s_waitcnt vmcnt(12)
    v_mfma_f32_32x32x16_bf16 v[48:63], v[112:115], a[88:91], v[48:63]
    ds_read_b64_tr_b16 v[96:97], v22 offset:30720
    ds_read_b64_tr_b16 v[98:99], v22 offset:31488
    buffer_load_dword v26, v185, s[32:35], 0 offen sc1
    v_mfma_f32_32x32x16_bf16 v[32:47], v[108:111], a[88:91], v[32:47]
    ds_read_b64_tr_b16 v[100:101], v22 offset:30784
    ds_read_b64_tr_b16 v[102:103], v22 offset:31552
    s_lshl_b32 s67, s2, 2
    s_add_u32 s67, s67, s44
    s_mul_i32 s67, s67, 1664
    v_min_u32 v18, 12, v0
    v_lshlrev_b32 v18, 7, v18
    buffer_load_dword v26, v18, s[16:19], s67 offen
    v_mfma_f32_32x32x16_bf16 v[64:79], a[88:91], v[116:119], v[64:79]
    ds_read_b64_tr_b16 v[104:105], v22 offset:30848
    ds_read_b64_tr_b16 v[106:107], v22 offset:31616
    v_add_f32 v82, v82, v90
    v_add_f32 v83, v83, v91
    s_waitcnt vmcnt(13) lgkmcnt(6)
    v_mfma_f32_32x32x16_bf16 v[48:63], v[124:127], a[92:95], v[48:63]
    ds_read_b64_tr_b16 v[108:109], v22 offset:33792
    ds_read_b64_tr_b16 v[110:111], v22 offset:34560
    buffer_load_dword v26, off, s[28:31], s86 sc1
    v_mfma_f32_32x32x16_bf16 v[32:47], v[120:123], a[92:95], v[32:47]
    ds_read_b64_tr_b16 v[112:113], v22 offset:33856
    ds_read_b64_tr_b16 v[114:115], v22 offset:34624
    v_add_f32 v84, v84, v92
    v_add_f32 v85, v85, v93
    v_add_f32 v86, v86, v94
    v_mfma_f32_32x32x16_bf16 v[64:79], a[92:95], v[128:131], v[64:79]
    ds_read_b64_tr_b16 v[116:117], v22 offset:33920
    ds_read_b64_tr_b16 v[118:119], v22 offset:34688
    v_add_f32 v87, v87, v95
    v_add_f32 v80, v80, v84
    s_waitcnt vmcnt(13) lgkmcnt(6)
    v_mfma_f32_32x32x16_bf16 v[48:63], v[100:103], a[96:99], v[48:63]
    ds_read_b64_tr_b16 v[120:121], v22 offset:36864
    ds_read_b64_tr_b16 v[122:123], v22 offset:37632
    s_add_u32 m0, s61, 86016
    s_add_u32 s87, s87, s66
    buffer_load_dwordx4 v4, s[56:59], s87 offen offset:0 lds
    v_mfma_f32_32x32x16_bf16 v[32:47], v[96:99], a[96:99], v[32:47]
    ds_read_b64_tr_b16 v[124:125], v22 offset:36928
    ds_read_b64_tr_b16 v[126:127], v22 offset:37696
    buffer_load_dwordx4 v5, s[56:59], s87 offen offset:1024 lds
    v_mfma_f32_32x32x16_bf16 v[64:79], a[96:99], v[104:107], v[64:79]
    ds_read_b64_tr_b16 v[128:129], v22 offset:36992
    ds_read_b64_tr_b16 v[130:131], v22 offset:37760
    v_add_f32 v81, v81, v85
    v_add_f32 v82, v82, v86
    s_waitcnt vmcnt(14) lgkmcnt(6)
    v_mfma_f32_32x32x16_bf16 v[48:63], v[112:115], a[100:103], v[48:63]
    ds_read_b64_tr_b16 v[100:101], v22 offset:40000
    ds_read_b64_tr_b16 v[102:103], v22 offset:40768
    ds_read_b64_tr_b16 v[104:105], v22 offset:40064
    ds_read_b64_tr_b16 v[106:107], v22 offset:40832
    s_waitcnt vmcnt(13) lgkmcnt(4)
    v_mfma_f32_32x32x16_bf16 v[48:63], v[124:127], a[104:107], v[48:63]
    ds_read_b64_tr_b16 v[96:97], v22 offset:39936
    ds_read_b64_tr_b16 v[98:99], v22 offset:40704
    buffer_load_dwordx4 v6, s[56:59], s87 offen offset:2048 lds
    v_mfma_f32_32x32x16_bf16 v[64:79], a[100:103], v[116:119], v[64:79]
    v_add_f32 v83, v83, v87
    v_cvt_pk_bf16_f32 v84, v80, v81
    v_cvt_pk_bf16_f32 v85, v82, v83
    ds_write_b64 v248, v[84:85]
    s_waitcnt vmcnt(13) lgkmcnt(5)
    v_mfma_f32_32x32x16_bf16 v[48:63], v[100:103], a[108:111], v[48:63]
    buffer_load_dwordx4 v7, s[56:59], s87 offen offset:3072 lds
    v_mfma_f32_32x32x16_bf16 v[64:79], a[104:107], v[128:131], v[64:79]
    s_waitcnt lgkmcnt(1)
    v_mfma_f32_32x32x16_bf16 v[64:79], a[108:111], v[104:107], v[64:79]
    s_mov_b32 s80, 0x3e8b97f6
    s_mov_b32 s81, s80
    s_bfe_u32 s64, s62, s64
    s_lshl_b32 s75, s64, 12
    s_mul_i32 s64, s65, -6
    s_add_u32 s64, s64, 196626
    s_nop 1
    v_cvt_pk_bf16_f32 v204, v48, v49
    v_cvt_pk_bf16_f32 v205, v50, v51
    v_cvt_pk_bf16_f32 v206, v52, v53
    v_cvt_pk_bf16_f32 v207, v54, v55
    v_mfma_f32_32x32x16_bf16 v[32:47], v[108:111], a[100:103], v[32:47]
    ds_write_b128 v250, v[204:207] offset:20480
    v_cvt_pk_bf16_f32 v208, v56, v57
    v_cvt_pk_bf16_f32 v209, v58, v59
    v_cvt_pk_bf16_f32 v210, v60, v61
    v_cvt_pk_bf16_f32 v211, v62, v63
    v_mfma_f32_32x32x16_bf16 v[32:47], v[120:123], a[104:107], v[32:47]
    ds_write_b128 v250, v[208:211] offset:21504
    v_cvt_pk_bf16_f32 v218, v76, v77
    v_cvt_pk_bf16_f32 v219, v78, v79
    v_mfma_f32_32x32x16_bf16 v[32:47], v[96:99], a[108:111], v[32:47]
    ds_write_b64 v251, v[218:219] offset:1024
    v_cvt_pk_bf16_f32 v212, v64, v65
    v_cvt_pk_bf16_f32 v213, v66, v67
    v_cvt_pk_bf16_f32 v214, v68, v69
    v_cvt_pk_bf16_f32 v215, v70, v71
    v_cvt_pk_bf16_f32 v216, v72, v73
    v_cvt_pk_bf16_f32 v217, v74, v75
    s_waitcnt lgkmcnt(0)
    s_barrier
    ds_read_b128 v[220:223], v250 offset:16384
    ds_read_b128 v[224:227], v250 offset:17408
    ds_read_b64 v[228:229], v251
    v_cvt_pk_bf16_f32 v196, v32, v33
    v_cvt_pk_bf16_f32 v197, v34, v35
    v_cvt_pk_bf16_f32 v198, v36, v37
    v_cvt_pk_bf16_f32 v199, v38, v39
    v_cvt_pk_bf16_f32 v200, v40, v41
    v_cvt_pk_bf16_f32 v201, v42, v43
    v_mfma_f32_32x32x16_bf16 v[164:179], v[204:207], v[196:199], v[164:179]
    v_cvt_pk_bf16_f32 v202, v44, v45
    v_cvt_pk_bf16_f32 v203, v46, v47
    v_and_b32 v202, v249, v202
    v_and_b32 v203, v249, v203
    s_waitcnt lgkmcnt(1)
    s_nop 0
    v_mfma_f32_32x32x16_bf16 v[164:179], v[208:211], v[200:203], v[164:179]
    s_add_u32 m0, s61, 90112
    s_add_u32 s87, s87, s60
    buffer_load_dwordx4 v4, s[56:59], s87 offen offset:0 lds
    v_mfma_f32_32x32x16_bf16 v[180:195], v[220:223], v[196:199], v[180:195]
    s_bfe_u32 s64, s62, s64
    s_lshl_b32 s76, s64, 12
    v_add_u32 v18, 57344, v16
    v_add_u32 v19, 57344, v17
    v_bfe_u32 v25, v0, 4, 1
    v_mfma_f32_32x32x16_bf16 v[180:195], v[224:227], v[200:203], v[180:195]
    buffer_load_dwordx4 v5, s[56:59], s87 offen offset:1024 lds
    v_mul_u32_u24 v22, 14336, v25
    v_add_u32 v22, v22, v30
    v_mul_u32_u24 v25, 3584, v25
    v_add_u32 v21, v25, v30
    v_max3_f32 v80, v164, v168, v172
    v_max3_f32 v81, v165, v169, v173
    v_max3_f32 v82, v166, v170, v174
    v_max3_f32 v83, v167, v171, v175
    s_nop 2
    v_max3_f32 v80, v80, v176, v192
    v_max3_f32 v81, v81, v177, v193
    v_max3_f32 v82, v82, v178, v194
    v_max3_f32 v83, v83, v179, v195
    v_max3_f32 v84, v80, v81, v82
    v_max_f32 v85, v84, v83
    v_max_f32 v84, v84, v83
    s_nop 1
    v_permlane32_swap_b32 v84, v85
    v_max_f32 v84, v84, v85
    v_mul_f32 v84, s80, v84
    v_pk_fma_f32 v[80:81], v[80:81], s[80:81], v[84:85] op_sel_hi:[1,1,0] neg_lo:[0,0,1] neg_hi:[0,0,1]
    v_pk_fma_f32 v[82:83], v[82:83], s[80:81], v[84:85] op_sel_hi:[1,1,0] neg_lo:[0,0,1] neg_hi:[0,0,1]
    v_exp_f32 v80, v80
    v_exp_f32 v81, v81
    v_exp_f32 v82, v82
    v_exp_f32 v83, v83
    v_cvt_pk_bf16_f32 v86, v80, v81
    v_cvt_pk_bf16_f32 v87, v82, v83
    v_and_b32 v232, v232, v86
    v_and_b32 v233, v233, v87
    v_and_b32 v234, v234, v86
    v_and_b32 v235, v235, v87
    v_and_b32 v236, v236, v86
    v_and_b32 v237, v237, v87
    v_mfma_f32_32x32x16_bf16 v[32:47], v[212:215], v[232:235], 0
    v_and_b32 v238, v238, v86
    v_and_b32 v239, v239, v87
    v_and_b32 v240, v240, v86
    v_and_b32 v241, v241, v87
    v_add_f32 v80, v80, v81
    v_add_f32 v82, v82, v83
    v_mfma_f32_32x32x16_bf16 v[32:47], v[216:219], v[236:239], v[32:47]
    v_add_f32 v84, v80, v82
    v_add_f32 v85, v80, v82
    s_waitcnt lgkmcnt(0)
    buffer_load_dwordx4 v6, s[56:59], s87 offen offset:2048 lds
    v_mfma_f32_32x32x16_bf16 v[32:47], v[228:231], v[240:243], v[32:47]
    v_permlane32_swap_b32 v84, v85
    v_add_f32 v84, v84, v85
    v_rcp_f32 v84, v84
    s_add_u32 m0, s89, 28672
    s_nop 0
    buffer_load_dwordx4 v8, s[16:19], s8 offen offset:0 lds
    buffer_load_dwordx4 v9, s[16:19], s8 offen offset:1024 lds
    v_and_b32 v29, 15, v0
    v_min_u32 v29, 13, v29
    v_lshlrev_b32 v29, 2, v29
    s_nop 1
    v_pk_mul_f32 v[32:33], v[32:33], v[84:85] op_sel_hi:[1,0]
    v_pk_mul_f32 v[34:35], v[34:35], v[84:85] op_sel_hi:[1,0]
    v_pk_mul_f32 v[36:37], v[36:37], v[84:85] op_sel_hi:[1,0]
    v_pk_mul_f32 v[38:39], v[38:39], v[84:85] op_sel_hi:[1,0]
    v_cvt_pk_bf16_f32 v196, v32, v33
    v_cvt_pk_bf16_f32 v197, v34, v35
    v_cvt_pk_bf16_f32 v198, v36, v37
    v_cvt_pk_bf16_f32 v199, v38, v39
    buffer_store_dwordx4 v[196:199], v2, s[32:35], s94 offen offset:0
    v_pk_mul_f32 v[40:41], v[40:41], v[84:85] op_sel_hi:[1,0]
    v_pk_mul_f32 v[42:43], v[42:43], v[84:85] op_sel_hi:[1,0]
    v_pk_mul_f32 v[44:45], v[44:45], v[84:85] op_sel_hi:[1,0]
    v_pk_mul_f32 v[46:47], v[46:47], v[84:85] op_sel_hi:[1,0]
    v_cvt_pk_bf16_f32 v200, v40, v41
    v_cvt_pk_bf16_f32 v201, v42, v43
    v_cvt_pk_bf16_f32 v202, v44, v45
    v_cvt_pk_bf16_f32 v203, v46, v47
    v_and_b32 v202, v249, v202
    v_and_b32 v203, v249, v203
    buffer_store_dwordx4 v[200:203], v2, s[32:35], s94 offen offset:1024
    s_cmp_lt_u32 s43, 14
    s_cbranch_scc0 L_IDLE
    s_mov_b32 s67, 69120
    buffer_load_dword v148, v31, s[32:35], s67 offen sc1
    s_mov_b32 s67, 79872
    buffer_load_dword v149, v31, s[32:35], s67 offen sc1
    s_mov_b32 s67, 90624
    buffer_load_dword v150, v31, s[32:35], s67 offen sc1
    s_mov_b32 s67, 101376
    buffer_load_dword v151, v31, s[32:35], s67 offen sc1
    global_load_ushort v152, v20, s[38:39]
    s_lshr_b32 s67, s54, 1
    s_add_u32 m0, s67, 145920
    s_add_u32 s67, s86, 13312
    buffer_load_dwordx4 v28, s[4:7], s86 offen lds
    buffer_load_dwordx4 v28, s[4:7], s67 offen offset:1024 lds
    s_waitcnt vmcnt(11)
    s_barrier
    s_add_u32 m0, s89, 28672
    s_nop 0
    buffer_load_dwordx4 v10, s[16:19], s8 offen offset:2048 lds
    ds_read_b64_tr_b16 a[0:1], v157 offset:0
    ds_read_b64_tr_b16 a[2:3], v157 offset:1024
    ds_read_b64_tr_b16 a[4:5], v158 offset:0
    ds_read_b64_tr_b16 a[6:7], v158 offset:1024
    ds_read_b64_tr_b16 a[8:9], v159 offset:0
    ds_read_b64_tr_b16 a[10:11], v159 offset:1024
    ds_read_b64_tr_b16 a[12:13], v160 offset:0
    ds_read_b64_tr_b16 a[14:15], v160 offset:1024
    buffer_load_dwordx4 v11, s[16:19], s8 offen offset:3072 lds
    ds_read_b64_tr_b16 a[16:17], v158 offset:3584
    ds_read_b64_tr_b16 a[18:19], v158 offset:4608
    ds_read_b64_tr_b16 a[20:21], v157 offset:3584
    ds_read_b64_tr_b16 a[22:23], v157 offset:4608
    ds_read_b64_tr_b16 a[24:25], v160 offset:3584
    ds_read_b64_tr_b16 a[26:27], v160 offset:4608
    ds_read_b64_tr_b16 a[28:29], v159 offset:3584
    ds_read_b64_tr_b16 a[30:31], v159 offset:4608
    s_cmp_eq_u32 s47, 0
    s_cbranch_scc1 PS_20
    s_mov_b64 exec, 1
    s_waitcnt vmcnt(9)
    buffer_store_dword v3, off, s[32:35], s95
    s_mov_b64 exec, -1
PR_21:
    s_add_u32 m0, s89, 32768
    s_add_u32 s8, s8, 114688
    buffer_load_dwordx4 v8, s[16:19], s8 offen offset:0 lds
    ds_read_b64_tr_b16 a[32:33], v157 offset:7168
    ds_read_b64_tr_b16 a[34:35], v157 offset:8192
    ds_read_b64_tr_b16 a[36:37], v158 offset:7168
    ds_read_b64_tr_b16 a[38:39], v158 offset:8192
    ds_read_b64_tr_b16 a[40:41], v159 offset:7168
    ds_read_b64_tr_b16 a[42:43], v159 offset:8192
    ds_read_b64_tr_b16 a[44:45], v160 offset:7168
    ds_read_b64_tr_b16 a[46:47], v160 offset:8192
    buffer_load_dwordx4 v9, s[16:19], s8 offen offset:1024 lds
    ds_read_b64_tr_b16 a[48:49], v158 offset:10752
    ds_read_b64_tr_b16 a[50:51], v158 offset:11776
    ds_read_b64_tr_b16 a[52:53], v157 offset:10752
    ds_read_b64_tr_b16 a[54:55], v157 offset:11776
    ds_read_b64_tr_b16 a[56:57], v160 offset:10752
    ds_read_b64_tr_b16 a[58:59], v160 offset:11776
    ds_read_b64_tr_b16 a[60:61], v159 offset:10752
    ds_read_b64_tr_b16 a[62:63], v159 offset:11776
    buffer_load_dwordx4 v10, s[16:19], s8 offen offset:2048 lds
    ds_read_b64_tr_b16 a[64:65], v157 offset:14336
    ds_read_b64_tr_b16 a[66:67], v157 offset:15360
    ds_read_b64_tr_b16 a[68:69], v158 offset:14336
    ds_read_b64_tr_b16 a[70:71], v158 offset:15360
    ds_read_b64_tr_b16 a[72:73], v159 offset:14336
    ds_read_b64_tr_b16 a[74:75], v159 offset:15360
    ds_read_b64_tr_b16 a[76:77], v160 offset:14336
    ds_read_b64_tr_b16 a[78:79], v160 offset:15360
    s_add_u32 m0, s61, 28672
    s_add_u32 s8, s8, s68
    buffer_load_dwordx4 v8, s[16:19], s8 offen offset:0 lds
    ds_read_b64_tr_b16 a[80:81], v158 offset:17920
    ds_read_b64_tr_b16 a[82:83], v158 offset:18944
    ds_read_b64_tr_b16 a[84:85], v157 offset:17920
    ds_read_b64_tr_b16 a[86:87], v157 offset:18944
    ds_read_b64_tr_b16 a[88:89], v160 offset:17920
    ds_read_b64_tr_b16 a[90:91], v160 offset:18944
    ds_read_b64_tr_b16 a[92:93], v159 offset:17920
    ds_read_b64_tr_b16 a[94:95], v159 offset:18944
    buffer_load_dword v24, v23, s[32:35], 0 offen offset:0 sc1
    buffer_load_dwordx4 v9, s[16:19], s8 offen offset:1024 lds
    ds_read_b64_tr_b16 a[96:97], v157 offset:21504
    ds_read_b64_tr_b16 a[98:99], v157 offset:22528
    ds_read_b64_tr_b16 a[100:101], v158 offset:21504
    ds_read_b64_tr_b16 a[102:103], v158 offset:22528
    ds_read_b64_tr_b16 a[104:105], v159 offset:21504
    ds_read_b64_tr_b16 a[106:107], v159 offset:22528
    ds_read_b64_tr_b16 a[108:109], v160 offset:21504
    ds_read_b64_tr_b16 a[110:111], v160 offset:22528
    buffer_load_dwordx4 v10, s[16:19], s8 offen offset:2048 lds
    ds_read_b64_tr_b16 a[112:113], v158 offset:25088
    ds_read_b64_tr_b16 a[114:115], v158 offset:26112
    ds_read_b64_tr_b16 a[116:117], v157 offset:25088
    ds_read_b64_tr_b16 a[118:119], v157 offset:26112
    ds_read_b64_tr_b16 a[120:121], v160 offset:25088
    ds_read_b64_tr_b16 a[122:123], v160 offset:26112
    ds_read_b64_tr_b16 a[124:125], v159 offset:25088
    ds_read_b64_tr_b16 a[126:127], v159 offset:26112
    buffer_load_dwordx4 v11, s[16:19], s8 offen offset:3072 lds
    ds_read_b64_tr_b16 a[128:129], v157 offset:28672
    ds_read_b64_tr_b16 a[130:131], v157 offset:29696
    ds_read_b64_tr_b16 a[132:133], v158 offset:28672
    ds_read_b64_tr_b16 a[134:135], v158 offset:29696
    ds_read_b64_tr_b16 a[136:137], v159 offset:28672
    ds_read_b64_tr_b16 a[138:139], v159 offset:29696
    ds_read_b64_tr_b16 a[140:141], v160 offset:28672
    ds_read_b64_tr_b16 a[142:143], v160 offset:29696
    s_add_u32 m0, s61, 32768
    s_add_u32 s8, s8, 114688
    buffer_load_dwordx4 v8, s[16:19], s8 offen offset:0 lds
    ds_read_b64_tr_b16 a[144:145], v158 offset:32256
    ds_read_b64_tr_b16 a[146:147], v158 offset:33280
    ds_read_b64_tr_b16 a[148:149], v157 offset:32256
    ds_read_b64_tr_b16 a[150:151], v157 offset:33280
    ds_read_b64_tr_b16 a[152:153], v160 offset:32256
    ds_read_b64_tr_b16 a[154:155], v160 offset:33280
    ds_read_b64_tr_b16 a[156:157], v159 offset:32256
    ds_read_b64_tr_b16 a[158:159], v159 offset:33280
    buffer_load_dwordx4 v9, s[16:19], s8 offen offset:1024 lds
    buffer_load_dwordx4 v10, s[16:19], s8 offen offset:2048 lds
    buffer_load_dword v26, v23, s[32:35], 0 offen offset:0 sc1
    v_and_b32 v154, 3, v0
    v_lshlrev_b32 v154, 3, v154
    v_lshrrev_b32 v154, v154, v3
    s_waitcnt vmcnt(17)
    v_bitop3_b32 v155, v148, v149, v154 bitop3:0x7e
    v_bitop3_b32 v156, v150, v151, v154 bitop3:0x7e
    v_or_b32 v155, v155, v156
    v_and_b32 v155, 0xff, v155
    v_cmp_eq_u32 vcc, 0, v155
    s_nop 0
    s_cmp_eq_u64 vcc, -1
    s_cbranch_scc0 RC_18
RB_19:
    v_and_b32 v148, 0xffffff00, v148
    v_and_b32 v149, 0xffffff00, v149
    v_and_b32 v150, 0xffffff00, v150
    v_and_b32 v151, 0xffffff00, v151
    v_add_f32 v148, v148, v150
    v_add_f32 v149, v149, v151
    v_add_f32 v148, v148, v149
    v_cvt_pk_bf16_f32 v148, v148, v148
    s_cmp_eq_u32 s44, 2
    s_cselect_b32 s62, 1.0, 0
    v_and_b32 v148, 0xffff0000, v148
    v_add_f32 v148, s62, v148
    v_cvt_pk_bf16_f32 v148, v148, v148
    v_lshlrev_b32 v154, 2, v0
    v_add_u32 v154, 143872, v154
    s_lshl_b32 s62, s44, 8
    v_and_b32 v148, 0xffff0000, v148
    v_add_u32 v155, s62, v154
    v_lshlrev_b32 v152, 16, v152
    v_mul_f32 v152, v152, v148
    ds_write_b32 v155, v148
    ds_write_b32 v155, v152 offset:10240
    s_lshl_b32 s62, s44, 7
    s_add_u32 s62, s62, 145152
    v_lshl_add_u32 v155, v0, 1, s62
    ds_write_b16_d16_hi v155, v148
    ds_write_b32 v154, v252 offset:1792
    s_waitcnt vmcnt(7)
    v_cmp_eq_u32 vcc, s46, v24
    s_nop 0
    s_and_b32 s62, vcc_lo, s47
    s_cmp_eq_u32 s62, -1
    s_cbranch_scc0 PA_22
PD_23:
    buffer_load_dwordx4 v[32:35], v27, s[32:35], s10 offen offset:0 sc1
    ds_read_b64_tr_b16 a[160:161], v157 offset:35840
    ds_read_b64_tr_b16 a[162:163], v157 offset:36864
    ds_read_b64_tr_b16 a[164:165], v158 offset:35840
    ds_read_b64_tr_b16 a[166:167], v158 offset:36864
    ds_read_b64_tr_b16 a[168:169], v159 offset:35840
    ds_read_b64_tr_b16 a[170:171], v159 offset:36864
    ds_read_b64_tr_b16 a[172:173], v160 offset:35840
    buffer_load_dwordx4 v[36:39], v27, s[32:35], s10 offen offset:2048 sc1
    s_add_u32 s10, s10, 4096
    ds_read_b64_tr_b16 a[174:175], v160 offset:36864
    ds_read_b64_tr_b16 a[176:177], v158 offset:39424
    ds_read_b64_tr_b16 a[178:179], v158 offset:40448
    ds_read_b64_tr_b16 a[180:181], v157 offset:39424
    ds_read_b64_tr_b16 a[182:183], v157 offset:40448
    ds_read_b64_tr_b16 a[184:185], v160 offset:39424
    ds_read_b64_tr_b16 a[186:187], v160 offset:40448
    buffer_load_dwordx4 v[40:43], v27, s[32:35], s10 offen offset:0 sc1
    ds_read_b64_tr_b16 a[188:189], v159 offset:39424
    ds_read_b64_tr_b16 a[190:191], v159 offset:40448
    ds_read_b64_tr_b16 a[192:193], v157 offset:43008
    ds_read_b64_tr_b16 a[194:195], v157 offset:44032
    ds_read_b64_tr_b16 a[196:197], v158 offset:43008
    ds_read_b64_tr_b16 a[198:199], v158 offset:44032
    ds_read_b64_tr_b16 a[200:201], v159 offset:43008
    buffer_load_dwordx4 v[44:47], v27, s[32:35], s10 offen offset:2048 sc1
    s_add_u32 s10, s10, 4096
    ds_read_b64_tr_b16 a[202:203], v159 offset:44032
    ds_read_b64_tr_b16 a[204:205], v160 offset:43008
    ds_read_b64_tr_b16 a[206:207], v160 offset:44032
    ds_read_b64_tr_b16 a[208:209], v158 offset:46592
    ds_read_b64_tr_b16 a[210:211], v158 offset:47616
    ds_read_b64_tr_b16 a[212:213], v157 offset:46592
    ds_read_b64_tr_b16 a[214:215], v157 offset:47616
    buffer_load_dwordx4 v[48:51], v27, s[32:35], s10 offen offset:0 sc1
    ds_read_b64_tr_b16 a[216:217], v160 offset:46592
    ds_read_b64_tr_b16 a[218:219], v160 offset:47616
    ds_read_b64_tr_b16 a[220:221], v159 offset:46592
    ds_read_b64_tr_b16 a[222:223], v159 offset:47616
    ds_read_b64_tr_b16 a[224:225], v157 offset:50176
    ds_read_b64_tr_b16 a[226:227], v157 offset:51200
    ds_read_b64_tr_b16 a[228:229], v158 offset:50176
    buffer_load_dwordx4 v[52:55], v27, s[32:35], s10 offen offset:2048 sc1
    s_add_u32 s10, s10, 4096
    ds_read_b64_tr_b16 a[230:231], v158 offset:51200
    ds_read_b64_tr_b16 a[232:233], v159 offset:50176
    ds_read_b64_tr_b16 a[234:235], v159 offset:51200
    ds_read_b64_tr_b16 a[236:237], v160 offset:50176
    ds_read_b64_tr_b16 a[238:239], v160 offset:51200
    ds_read_b64_tr_b16 a[240:241], v158 offset:53760
    ds_read_b64_tr_b16 a[242:243], v158 offset:54784
    s_waitcnt vmcnt(5) lgkmcnt(14)
    v_mfma_f32_16x16x32_bf16 v[96:99], a[0:3], v[32:35], 0
    buffer_load_dwordx4 v[56:59], v27, s[32:35], s10 offen offset:0 sc1
    v_mfma_f32_16x16x32_bf16 v[100:103], a[4:7], v[32:35], 0
    ds_read_b64_tr_b16 a[244:245], v157 offset:53760
    v_mfma_f32_16x16x32_bf16 v[104:107], a[8:11], v[32:35], 0
    ds_read_b64_tr_b16 a[246:247], v157 offset:54784
    v_mfma_f32_16x16x32_bf16 v[108:111], a[12:15], v[32:35], 0
    s_waitcnt vmcnt(5) lgkmcnt(14)
    v_mfma_f32_16x16x32_bf16 v[96:99], a[16:19], v[36:39], v[96:99]
    buffer_load_dwordx4 v[60:63], v27, s[32:35], s10 offen offset:2048 sc1
    s_add_u32 s10, s10, 4096
    v_mfma_f32_16x16x32_bf16 v[100:103], a[20:23], v[36:39], v[100:103]
    ds_read_b64_tr_b16 a[248:249], v160 offset:53760
    v_mfma_f32_16x16x32_bf16 v[104:107], a[24:27], v[36:39], v[104:107]
    ds_read_b64_tr_b16 a[250:251], v160 offset:54784
    v_mfma_f32_16x16x32_bf16 v[108:111], a[28:31], v[36:39], v[108:111]
    s_waitcnt vmcnt(5) lgkmcnt(14)
    v_mfma_f32_16x16x32_bf16 v[96:99], a[32:35], v[40:43], v[96:99]
    buffer_load_dwordx4 v[64:67], v27, s[32:35], s10 offen offset:0 sc1
    v_mfma_f32_16x16x32_bf16 v[100:103], a[36:39], v[40:43], v[100:103]
    ds_read_b64_tr_b16 a[252:253], v159 offset:53760
    v_mfma_f32_16x16x32_bf16 v[104:107], a[40:43], v[40:43], v[104:107]
L_STUB3:
    s_cbranch_execz L_STUB7
    ds_read_b64_tr_b16 a[254:255], v159 offset:54784
    v_mfma_f32_16x16x32_bf16 v[108:111], a[44:47], v[40:43], v[108:111]
    s_waitcnt vmcnt(5) lgkmcnt(14)
    v_mfma_f32_16x16x32_bf16 v[96:99], a[48:51], v[44:47], v[96:99]
    buffer_load_dwordx4 v[68:71], v27, s[32:35], s10 offen offset:2048 sc1
    s_add_u32 s10, s10, 4096
    v_mfma_f32_16x16x32_bf16 v[100:103], a[52:55], v[44:47], v[100:103]
    ds_read_b64 v[196:197], v161 offset:0
    v_mfma_f32_16x16x32_bf16 v[104:107], a[56:59], v[44:47], v[104:107]
    ds_read_b64 v[198:199], v161 offset:32
    v_mfma_f32_16x16x32_bf16 v[108:111], a[60:63], v[44:47], v[108:111]
    s_waitcnt vmcnt(5) lgkmcnt(14)
    v_mfma_f32_16x16x32_bf16 v[96:99], a[64:67], v[48:51], v[96:99]
    buffer_load_dwordx4 v[72:75], v27, s[32:35], s10 offen offset:0 sc1
    v_mfma_f32_16x16x32_bf16 v[100:103], a[68:71], v[48:51], v[100:103]
    ds_read_b64 v[200:201], v161 offset:64
    v_mfma_f32_16x16x32_bf16 v[104:107], a[72:75], v[48:51], v[104:107]
    ds_read_b64 v[202:203], v161 offset:96
    v_mfma_f32_16x16x32_bf16 v[108:111], a[76:79], v[48:51], v[108:111]
    s_waitcnt vmcnt(5) lgkmcnt(4)
    s_barrier
    v_mfma_f32_16x16x32_bf16 v[96:99], a[80:83], v[52:55], v[96:99]
    buffer_load_dwordx4 v[76:79], v27, s[32:35], s10 offen offset:2048 sc1
    s_add_u32 s10, s10, 4096
    v_mfma_f32_16x16x32_bf16 v[100:103], a[84:87], v[52:55], v[100:103]
    ds_read_b128 v[144:147], v163 offset:0
    v_mfma_f32_16x16x32_bf16 v[104:107], a[88:91], v[52:55], v[104:107]
    ds_read_b128 v[148:151], v163 offset:64
    v_mfma_f32_16x16x32_bf16 v[108:111], a[92:95], v[52:55], v[108:111]
    s_waitcnt vmcnt(5)
    ds_read_b128 v[128:131], v162 offset:0
    v_mfma_f32_16x16x32_bf16 v[96:99], a[96:99], v[56:59], v[96:99]
    buffer_load_dwordx4 v[80:83], v27, s[32:35], s10 offen offset:0 sc1
    v_mfma_f32_16x16x32_bf16 v[100:103], a[100:103], v[56:59], v[100:103]
    ds_read_b128 v[132:135], v162 offset:64
    v_mfma_f32_16x16x32_bf16 v[104:107], a[104:107], v[56:59], v[104:107]
    ds_read_b128 v[136:139], v162 offset:128
    v_mfma_f32_16x16x32_bf16 v[108:111], a[108:111], v[56:59], v[108:111]
    s_waitcnt vmcnt(5)
    ds_read_b128 v[140:143], v162 offset:192
    v_mfma_f32_16x16x32_bf16 v[96:99], a[112:115], v[60:63], v[96:99]
    buffer_load_dwordx4 v[84:87], v27, s[32:35], s10 offen offset:2048 sc1
    s_add_u32 s10, s10, 4096
    v_mfma_f32_16x16x32_bf16 v[100:103], a[116:119], v[60:63], v[100:103]
    ds_read_b128 v[164:167], v162 offset:512
    v_mfma_f32_16x16x32_bf16 v[104:107], a[120:123], v[60:63], v[104:107]
    ds_read_b128 v[168:171], v162 offset:576
    v_mfma_f32_16x16x32_bf16 v[108:111], a[124:127], v[60:63], v[108:111]
    s_waitcnt vmcnt(5)
    ds_read_b128 v[172:175], v162 offset:640
    v_mfma_f32_16x16x32_bf16 v[96:99], a[128:131], v[64:67], v[96:99]
    buffer_load_dwordx4 v[88:91], v27, s[32:35], s10 offen offset:0 sc1
    v_mfma_f32_16x16x32_bf16 v[100:103], a[132:135], v[64:67], v[100:103]
    ds_read_b128 v[176:179], v162 offset:704
    v_mfma_f32_16x16x32_bf16 v[104:107], a[136:139], v[64:67], v[104:107]
    s_waitcnt lgkmcnt(10)
    v_mfma_f32_16x16x32_bf16 v[108:111], a[140:143], v[64:67], v[108:111]
    s_waitcnt vmcnt(5)
    v_lshlrev_b32 v112, 16, v196
    v_and_b32 v113, 0xffff0000, v196
    v_mfma_f32_16x16x32_bf16 v[96:99], a[144:147], v[68:71], v[96:99]
    buffer_load_dwordx4 v[92:95], v27, s[32:35], s10 offen offset:2048 sc1
    v_mfma_f32_16x16x32_bf16 v[100:103], a[148:151], v[68:71], v[100:103]
    v_lshlrev_b32 v114, 16, v197
    v_and_b32 v115, 0xffff0000, v197
    v_mfma_f32_16x16x32_bf16 v[104:107], a[152:155], v[68:71], v[104:107]
    v_lshlrev_b32 v116, 16, v198
    v_and_b32 v117, 0xffff0000, v198
    v_mfma_f32_16x16x32_bf16 v[108:111], a[156:159], v[68:71], v[108:111]
    s_waitcnt vmcnt(5)
    v_lshlrev_b32 v118, 16, v199
    v_and_b32 v119, 0xffff0000, v199
    v_mfma_f32_16x16x32_bf16 v[96:99], a[160:163], v[72:75], v[96:99]
    s_add_u32 m0, s89, 86016
    s_nop 0
    buffer_load_dwordx4 v8, s[16:19], s9 offen offset:0 lds
    v_mfma_f32_16x16x32_bf16 v[100:103], a[164:167], v[72:75], v[100:103]
    v_lshlrev_b32 v120, 16, v200
    v_and_b32 v121, 0xffff0000, v200
    v_mfma_f32_16x16x32_bf16 v[104:107], a[168:171], v[72:75], v[104:107]
    v_lshlrev_b32 v122, 16, v201
    v_and_b32 v123, 0xffff0000, v201
    v_mfma_f32_16x16x32_bf16 v[108:111], a[172:175], v[72:75], v[108:111]
    s_waitcnt vmcnt(5)
    v_lshlrev_b32 v124, 16, v202
    v_and_b32 v125, 0xffff0000, v202
    v_mfma_f32_16x16x32_bf16 v[96:99], a[176:179], v[76:79], v[96:99]
    buffer_load_dwordx4 v9, s[16:19], s9 offen offset:1024 lds
    v_mfma_f32_16x16x32_bf16 v[100:103], a[180:183], v[76:79], v[100:103]
    v_lshlrev_b32 v126, 16, v203
    v_and_b32 v127, 0xffff0000, v203
    v_mfma_f32_16x16x32_bf16 v[104:107], a[184:187], v[76:79], v[104:107]
    ds_read_b128 v[180:183], v162 offset:256
    v_mfma_f32_16x16x32_bf16 v[108:111], a[188:191], v[76:79], v[108:111]
    s_waitcnt vmcnt(5)
    ds_read_b128 v[184:187], v162 offset:320
    v_mfma_f32_16x16x32_bf16 v[96:99], a[192:195], v[80:83], v[96:99]
    buffer_load_dwordx4 v10, s[16:19], s9 offen offset:2048 lds
    v_mfma_f32_16x16x32_bf16 v[100:103], a[196:199], v[80:83], v[100:103]
    ds_read_b128 v[188:191], v162 offset:384
    v_mfma_f32_16x16x32_bf16 v[104:107], a[200:203], v[80:83], v[104:107]
    ds_read_b128 v[192:195], v162 offset:448
    v_mfma_f32_16x16x32_bf16 v[108:111], a[204:207], v[80:83], v[108:111]
    s_waitcnt vmcnt(5)
    ds_read_b128 v[220:223], v162 offset:11008
    v_mfma_f32_16x16x32_bf16 v[96:99], a[208:211], v[84:87], v[96:99]
    buffer_load_dwordx4 v11, s[16:19], s9 offen offset:3072 lds
    v_mfma_f32_16x16x32_bf16 v[100:103], a[212:215], v[84:87], v[100:103]
    ds_read_b128 v[224:227], v162 offset:11072
    v_mfma_f32_16x16x32_bf16 v[104:107], a[216:219], v[84:87], v[104:107]
    ds_read_b128 v[228:231], v162 offset:11136
    v_mfma_f32_16x16x32_bf16 v[108:111], a[220:223], v[84:87], v[108:111]
    s_waitcnt vmcnt(5)
    ds_read_b128 v[232:235], v162 offset:11200
    v_mfma_f32_16x16x32_bf16 v[96:99], a[224:227], v[88:91], v[96:99]
    v_mfma_f32_16x16x32_bf16 v[100:103], a[228:231], v[88:91], v[100:103]
    v_mfma_f32_16x16x32_bf16 v[104:107], a[232:235], v[88:91], v[104:107]
    v_mfma_f32_16x16x32_bf16 v[108:111], a[236:239], v[88:91], v[108:111]
    s_waitcnt vmcnt(4)
    v_mfma_f32_16x16x32_bf16 v[96:99], a[240:243], v[92:95], v[96:99]
    v_mfma_f32_16x16x32_bf16 v[100:103], a[244:247], v[92:95], v[100:103]
    v_mfma_f32_16x16x32_bf16 v[104:107], a[248:251], v[92:95], v[104:107]
    v_mfma_f32_16x16x32_bf16 v[108:111], a[252:255], v[92:95], v[108:111]
    s_waitcnt lgkmcnt(14)
    v_mfma_f32_16x16x32_bf16 v[152:155], v[144:147], v[144:147], 0
    v_mfma_f32_16x16x32_bf16 v[152:155], v[148:151], v[148:151], v[152:155]
    s_waitcnt lgkmcnt(8)
    s_nop 0
    v_pk_fma_f32 v[96:97], v[96:97], v[128:129], v[112:113]
    v_pk_fma_f32 v[98:99], v[98:99], v[130:131], v[114:115]
    v_pk_fma_f32 v[100:101], v[100:101], v[132:133], v[116:117]
    v_pk_fma_f32 v[102:103], v[102:103], v[134:135], v[118:119]
    v_pk_mul_f32 v[236:237], v[96:97], v[164:165]
    v_pk_mul_f32 v[238:239], v[98:99], v[166:167]
    v_pk_mul_f32 v[240:241], v[100:101], v[168:169]
    v_pk_mul_f32 v[242:243], v[102:103], v[170:171]
    v_cvt_pk_bf16_f32 v196, v236, v237
    v_cvt_pk_bf16_f32 v197, v238, v239
    v_cvt_pk_bf16_f32 v198, v240, v241
    v_cvt_pk_bf16_f32 v199, v242, v243
    buffer_store_dwordx4 v[196:199], v2, s[32:35], s11 offen offset:0
    v_pk_fma_f32 v[104:105], v[104:105], v[136:137], v[120:121]
    v_pk_fma_f32 v[106:107], v[106:107], v[138:139], v[122:123]
    v_pk_fma_f32 v[108:109], v[108:109], v[140:141], v[124:125]
    v_pk_fma_f32 v[110:111], v[110:111], v[142:143], v[126:127]
    v_pk_mul_f32 v[244:245], v[104:105], v[172:173]
    v_pk_mul_f32 v[246:247], v[106:107], v[174:175]
    v_pk_mul_f32 v[248:249], v[108:109], v[176:177]
    v_pk_mul_f32 v[250:251], v[110:111], v[178:179]
    v_cvt_pk_bf16_f32 v200, v244, v245
    v_cvt_pk_bf16_f32 v201, v246, v247
    v_cvt_pk_bf16_f32 v202, v248, v249
    v_cvt_pk_bf16_f32 v203, v250, v251
    buffer_store_dwordx4 v[200:203], v2, s[32:35], s11 offen offset:1024
    s_waitcnt lgkmcnt(0)
    v_mov_b32 v47, v152
    v_pk_mul_f32 v[34:35], v[96:97], v[96:97]
    v_pk_mul_f32 v[38:39], v[236:237], v[236:237]
    v_pk_mul_f32 v[40:41], v[236:237], v[164:165]
    v_pk_mul_f32 v[42:43], v[236:237], v[180:181]
    v_pk_add_f32 v[32:33], v[96:97], v[98:99]
    v_pk_fma_f32 v[34:35], v[98:99], v[98:99], v[34:35]
    v_pk_add_f32 v[36:37], v[236:237], v[238:239]
    v_pk_fma_f32 v[38:39], v[238:239], v[238:239], v[38:39]
    v_pk_fma_f32 v[40:41], v[238:239], v[166:167], v[40:41]
    v_pk_fma_f32 v[42:43], v[238:239], v[182:183], v[42:43]
    s_add_u32 m0, s89, 90112
    s_add_u32 s9, s9, 114688
    buffer_load_dwordx4 v8, s[16:19], s9 offen offset:0 lds
    v_pk_add_f32 v[32:33], v[32:33], v[100:101]
    v_pk_fma_f32 v[34:35], v[100:101], v[100:101], v[34:35]
    v_pk_add_f32 v[36:37], v[36:37], v[240:241]
    v_pk_fma_f32 v[38:39], v[240:241], v[240:241], v[38:39]
    v_pk_fma_f32 v[40:41], v[240:241], v[168:169], v[40:41]
    v_pk_fma_f32 v[42:43], v[240:241], v[184:185], v[42:43]
    v_pk_add_f32 v[32:33], v[32:33], v[102:103]
    v_pk_fma_f32 v[34:35], v[102:103], v[102:103], v[34:35]
    v_pk_add_f32 v[36:37], v[36:37], v[242:243]
    v_pk_fma_f32 v[38:39], v[242:243], v[242:243], v[38:39]
    v_pk_fma_f32 v[40:41], v[242:243], v[170:171], v[40:41]
    v_pk_fma_f32 v[42:43], v[242:243], v[186:187], v[42:43]
    buffer_load_dwordx4 v9, s[16:19], s9 offen offset:1024 lds
    v_pk_add_f32 v[32:33], v[32:33], v[104:105]
    v_pk_fma_f32 v[34:35], v[104:105], v[104:105], v[34:35]
    v_pk_add_f32 v[36:37], v[36:37], v[244:245]
    v_pk_fma_f32 v[38:39], v[244:245], v[244:245], v[38:39]
    v_pk_fma_f32 v[40:41], v[244:245], v[172:173], v[40:41]
    v_pk_fma_f32 v[42:43], v[244:245], v[188:189], v[42:43]
    v_pk_add_f32 v[32:33], v[32:33], v[106:107]
    v_pk_fma_f32 v[34:35], v[106:107], v[106:107], v[34:35]
    v_pk_add_f32 v[36:37], v[36:37], v[246:247]
    v_pk_fma_f32 v[38:39], v[246:247], v[246:247], v[38:39]
    v_pk_fma_f32 v[40:41], v[246:247], v[174:175], v[40:41]
    v_pk_fma_f32 v[42:43], v[246:247], v[190:191], v[42:43]
    buffer_load_dwordx4 v10, s[16:19], s9 offen offset:2048 lds
    v_pk_add_f32 v[32:33], v[32:33], v[108:109]
    v_pk_fma_f32 v[34:35], v[108:109], v[108:109], v[34:35]
    v_pk_add_f32 v[36:37], v[36:37], v[248:249]
    v_pk_fma_f32 v[38:39], v[248:249], v[248:249], v[38:39]
    v_pk_fma_f32 v[40:41], v[248:249], v[176:177], v[40:41]
    v_pk_fma_f32 v[42:43], v[248:249], v[192:193], v[42:43]
    v_pk_add_f32 v[32:33], v[32:33], v[110:111]
    v_pk_fma_f32 v[34:35], v[110:111], v[110:111], v[34:35]
    v_pk_add_f32 v[36:37], v[36:37], v[250:251]
    v_pk_fma_f32 v[38:39], v[250:251], v[250:251], v[38:39]
    v_pk_fma_f32 v[40:41], v[250:251], v[178:179], v[40:41]
    v_pk_fma_f32 v[42:43], v[250:251], v[194:195], v[42:43]
    s_add_u32 m0, s61, 86016
    s_add_u32 s9, s9, s68
    buffer_load_dwordx4 v8, s[16:19], s9 offen offset:0 lds
    v_add_f32 v32, v32, v33
    v_add_f32 v38, v38, v39
    v_add_f32 v34, v34, v35
    v_add_f32 v40, v40, v41
    v_add_f32 v36, v36, v37
    v_add_f32 v42, v42, v43
    v_permlane32_swap_b32 v32, v38
    v_permlane32_swap_b32 v34, v40
    v_permlane32_swap_b32 v36, v42
    v_add_f32 v44, v32, v38
    v_add_f32 v48, v32, v38
    v_add_f32 v45, v34, v40
    v_add_f32 v49, v34, v40
    v_add_f32 v46, v36, v42
    v_add_f32 v50, v36, v42
    v_permlane16_swap_b32 v44, v48
    v_permlane16_swap_b32 v45, v49
    v_permlane16_swap_b32 v46, v50
    v_add_f32 v44, v44, v48
    v_add_f32 v45, v45, v49
    v_add_f32 v46, v46, v50
    s_mov_b32 s62, 0x3b124925
    v_pk_mul_f32 v[44:45], v[44:45], s[62:63] op_sel_hi:[1,0]
    v_pk_mul_f32 v[46:47], v[46:47], s[62:63] op_sel_hi:[1,0]
    buffer_store_dwordx4 v[44:47], v30, s[32:35], s96 offen
    s_cmp_eq_u32 s47, 0
    s_cbranch_scc1 PS_24
    s_mov_b64 exec, 1
    s_waitcnt vmcnt(5)
    buffer_store_dword v3, off, s[32:35], s13 offset:768
    s_mov_b64 exec, -1
PR_25:
    buffer_load_dwordx4 v9, s[16:19], s9 offen offset:1024 lds
    s_nop 0
    v_pk_add_f32 v[96:97], v[220:221], v[96:97]
    v_pk_add_f32 v[98:99], v[222:223], v[98:99]
    v_pk_add_f32 v[100:101], v[224:225], v[100:101]
    v_pk_add_f32 v[102:103], v[226:227], v[102:103]
    v_pk_add_f32 v[104:105], v[228:229], v[104:105]
    v_pk_add_f32 v[106:107], v[230:231], v[106:107]
    v_pk_add_f32 v[108:109], v[232:233], v[108:109]
    v_pk_add_f32 v[110:111], v[234:235], v[110:111]
    v_accvgpr_write_b32 a224, v96
    v_accvgpr_write_b32 a225, v97
    v_accvgpr_write_b32 a226, v98
    v_accvgpr_write_b32 a227, v99
    buffer_load_dwordx4 v10, s[16:19], s9 offen offset:2048 lds
    v_accvgpr_write_b32 a228, v100
    v_accvgpr_write_b32 a229, v101
    v_accvgpr_write_b32 a230, v102
    v_accvgpr_write_b32 a231, v103
    v_accvgpr_write_b32 a232, v104
    v_accvgpr_write_b32 a233, v105
    v_accvgpr_write_b32 a234, v106
    v_accvgpr_write_b32 a235, v107
    v_accvgpr_write_b32 a236, v108
    v_accvgpr_write_b32 a237, v109
    v_accvgpr_write_b32 a238, v110
    v_accvgpr_write_b32 a239, v111
    buffer_load_dwordx4 v11, s[16:19], s9 offen offset:3072 lds
    ds_read_b64_tr_b16 a[0:1], v16 offset:0
    ds_read_b64_tr_b16 a[2:3], v16 offset:2048
    ds_read_b64_tr_b16 a[112:113], v17 offset:0
    ds_read_b64_tr_b16 a[114:115], v17 offset:2048
    ds_read_b64_tr_b16 a[4:5], v16 offset:1024
    ds_read_b64_tr_b16 a[6:7], v16 offset:3072
    ds_read_b64_tr_b16 a[116:117], v17 offset:1024
    ds_read_b64_tr_b16 a[118:119], v17 offset:3072
    buffer_load_dword v24, v29, s[32:35], s90 offen offset:768 sc1
    s_add_u32 m0, s61, 90112
    s_add_u32 s9, s9, 114688
    buffer_load_dwordx4 v8, s[16:19], s9 offen offset:0 lds
    ds_read_b64_tr_b16 a[8:9], v16 offset:4096
    ds_read_b64_tr_b16 a[10:11], v16 offset:6144
    ds_read_b64_tr_b16 a[120:121], v17 offset:4096
    ds_read_b64_tr_b16 a[122:123], v17 offset:6144
    ds_read_b64_tr_b16 a[12:13], v16 offset:5120
    ds_read_b64_tr_b16 a[14:15], v16 offset:7168
    ds_read_b64_tr_b16 a[124:125], v17 offset:5120
    ds_read_b64_tr_b16 a[126:127], v17 offset:7168
    buffer_load_dwordx4 v9, s[16:19], s9 offen offset:1024 lds
    ds_read_b64_tr_b16 a[16:17], v16 offset:8192
    ds_read_b64_tr_b16 a[18:19], v16 offset:10240
    ds_read_b64_tr_b16 a[128:129], v17 offset:8192
    ds_read_b64_tr_b16 a[130:131], v17 offset:10240
    ds_read_b64_tr_b16 a[20:21], v16 offset:9216
    ds_read_b64_tr_b16 a[22:23], v16 offset:11264
    ds_read_b64_tr_b16 a[132:133], v17 offset:9216
    ds_read_b64_tr_b16 a[134:135], v17 offset:11264
    s_cmp_eq_u32 s47, 0
    s_cbranch_scc1 PS_26
    s_mov_b64 exec, 1
    s_waitcnt vmcnt(7)
    buffer_store_dword v3, off, s[32:35], s13 offset:2048
    s_mov_b64 exec, -1
PR_27:
    buffer_load_dwordx4 v10, s[16:19], s9 offen offset:2048 lds
    ds_read_b64_tr_b16 a[24:25], v16 offset:12288
    ds_read_b64_tr_b16 a[26:27], v16 offset:14336
    ds_read_b64_tr_b16 a[136:137], v17 offset:12288
    ds_read_b64_tr_b16 a[138:139], v17 offset:14336
    ds_read_b64_tr_b16 a[28:29], v16 offset:13312
    ds_read_b64_tr_b16 a[30:31], v16 offset:15360
    ds_read_b64_tr_b16 a[140:141], v17 offset:13312
    ds_read_b64_tr_b16 a[142:143], v17 offset:15360
    buffer_load_dword v26, v29, s[32:35], s90 offen offset:768 sc1
    ds_read_b64_tr_b16 a[32:33], v16 offset:16384
    ds_read_b64_tr_b16 a[34:35], v16 offset:18432
    ds_read_b64_tr_b16 a[144:145], v17 offset:16384
    ds_read_b64_tr_b16 a[146:147], v17 offset:18432
    ds_read_b64_tr_b16 a[36:37], v16 offset:17408
    ds_read_b64_tr_b16 a[38:39], v16 offset:19456
    ds_read_b64_tr_b16 a[148:149], v17 offset:17408
    ds_read_b64_tr_b16 a[150:151], v17 offset:19456
    ds_read_b64_tr_b16 a[40:41], v16 offset:20480
    ds_read_b64_tr_b16 a[42:43], v16 offset:22528
    ds_read_b64_tr_b16 a[152:153], v17 offset:20480
    ds_read_b64_tr_b16 a[154:155], v17 offset:22528
    ds_read_b64_tr_b16 a[44:45], v16 offset:21504
    ds_read_b64_tr_b16 a[46:47], v16 offset:23552
    ds_read_b64_tr_b16 a[156:157], v17 offset:21504
    ds_read_b64_tr_b16 a[158:159], v17 offset:23552
    s_waitcnt vmcnt(5)
    v_cmp_eq_u32 vcc, s46, v24
    s_nop 0
    s_and_b32 s62, vcc_lo, s47
    s_cmp_eq_u32 s62, -1
    s_cbranch_scc0 PA_28
PD_29:
    buffer_load_dwordx4 v[32:35], v22, s[32:35], s14 offen offset:0 sc1
    ds_read_b64_tr_b16 a[48:49], v16 offset:24576
    ds_read_b64_tr_b16 a[50:51], v16 offset:26624
    ds_read_b64_tr_b16 a[160:161], v17 offset:24576
    ds_read_b64_tr_b16 a[162:163], v17 offset:26624
    ds_read_b64_tr_b16 a[52:53], v16 offset:25600
    ds_read_b64_tr_b16 a[54:55], v16 offset:27648
    ds_read_b64_tr_b16 a[164:165], v17 offset:25600
    buffer_load_dwordx4 v[36:39], v22, s[32:35], s14 offen offset:512 sc1
    ds_read_b64_tr_b16 a[166:167], v17 offset:27648
    ds_read_b64_tr_b16 a[56:57], v16 offset:28672
    ds_read_b64_tr_b16 a[58:59], v16 offset:30720
    ds_read_b64_tr_b16 a[168:169], v17 offset:28672
    ds_read_b64_tr_b16 a[170:171], v17 offset:30720
    ds_read_b64_tr_b16 a[60:61], v16 offset:29696
    ds_read_b64_tr_b16 a[62:63], v16 offset:31744
    buffer_load_dwordx4 v[40:43], v22, s[32:35], s14 offen offset:1024 sc1
    ds_read_b64_tr_b16 a[172:173], v17 offset:29696
    ds_read_b64_tr_b16 a[174:175], v17 offset:31744
    ds_read_b64_tr_b16 a[64:65], v16 offset:32768
    ds_read_b64_tr_b16 a[66:67], v16 offset:34816
    ds_read_b64_tr_b16 a[176:177], v17 offset:32768
    ds_read_b64_tr_b16 a[178:179], v17 offset:34816
    ds_read_b64_tr_b16 a[68:69], v16 offset:33792
    s_waitcnt vmcnt(4)
    s_barrier
    buffer_load_dwordx4 v[44:47], v22, s[32:35], s14 offen offset:1536 sc1
    ds_read_b64_tr_b16 v[208:209], v18 offset:0
    ds_read_b64_tr_b16 v[210:211], v18 offset:2048
    ds_read_b64_tr_b16 v[212:213], v19 offset:0
    ds_read_b64_tr_b16 v[214:215], v19 offset:2048
    ds_read_b64_tr_b16 v[216:217], v18 offset:1024
    ds_read_b64_tr_b16 v[218:219], v18 offset:3072
    ds_read_b64_tr_b16 v[220:221], v19 offset:1024
    buffer_load_dwordx4 v[48:51], v22, s[32:35], s14 offen offset:2048 sc1
    ds_read_b64_tr_b16 v[222:223], v19 offset:3072
    ds_read_b64_tr_b16 a[70:71], v16 offset:35840
    ds_read_b64_tr_b16 a[180:181], v17 offset:33792
    ds_read_b64_tr_b16 a[182:183], v17 offset:35840
    ds_read_b64_tr_b16 a[72:73], v16 offset:36864
    ds_read_b64_tr_b16 a[74:75], v16 offset:38912
    ds_read_b64_tr_b16 a[184:185], v17 offset:36864
    buffer_load_dwordx4 v[52:55], v22, s[32:35], s14 offen offset:2560 sc1
    ds_read_b64_tr_b16 a[186:187], v17 offset:38912
    ds_read_b64_tr_b16 a[76:77], v16 offset:37888
    ds_read_b64_tr_b16 a[78:79], v16 offset:39936
    ds_read_b64_tr_b16 a[188:189], v17 offset:37888
    ds_read_b64_tr_b16 a[190:191], v17 offset:39936
    ds_read_b64_tr_b16 a[80:81], v16 offset:40960
    ds_read_b64_tr_b16 a[82:83], v16 offset:43008
    buffer_load_dword v24, v29, s[32:35], s90 offen offset:2048 sc1
    s_waitcnt vmcnt(6) lgkmcnt(14)
    v_mfma_f32_32x32x16_bf16 v[144:159], v[208:211], v[32:35], 0
    ds_read_b64_tr_b16 v[224:225], v18 offset:4096
    ds_read_b64_tr_b16 v[226:227], v18 offset:6144
    buffer_load_dwordx4 v[56:59], v22, s[32:35], s14 offen offset:3072 sc1
    v_mfma_f32_32x32x16_bf16 v[160:175], v[212:215], v[32:35], 0
    ds_read_b64_tr_b16 v[228:229], v19 offset:4096
    ds_read_b64_tr_b16 v[230:231], v19 offset:6144
    ds_read_b64_tr_b16 a[192:193], v17 offset:40960
    ds_read_b64_tr_b16 a[194:195], v17 offset:43008
    v_mfma_f32_32x32x16_bf16 v[176:191], a[0:3], v[32:35], 0
    buffer_load_dwordx4 v[60:63], v22, s[32:35], s14 offen offset:3584 sc1
    s_add_u32 s14, s14, 4096
    ds_read_b64_tr_b16 a[84:85], v16 offset:41984
    ds_read_b64_tr_b16 a[86:87], v16 offset:44032
    v_mfma_f32_32x32x16_bf16 v[192:207], a[112:115], v[32:35], 0
    ds_read_b64_tr_b16 a[196:197], v17 offset:41984
    ds_read_b64_tr_b16 a[198:199], v17 offset:44032
    ds_read_b64_tr_b16 a[88:89], v16 offset:45056
    ds_read_b64_tr_b16 a[90:91], v16 offset:47104
    s_waitcnt vmcnt(7) lgkmcnt(14)
    v_mfma_f32_32x32x16_bf16 v[144:159], v[216:219], v[36:39], v[144:159]
    ds_read_b64_tr_b16 v[208:209], v18 offset:5120
    ds_read_b64_tr_b16 v[210:211], v18 offset:7168
    buffer_load_dwordx4 v[64:67], v22, s[32:35], s14 offen offset:0 sc1
    v_mfma_f32_32x32x16_bf16 v[160:175], v[220:223], v[36:39], v[160:175]
    ds_read_b64_tr_b16 v[212:213], v19 offset:5120
    ds_read_b64_tr_b16 v[214:215], v19 offset:7168
    ds_read_b64_tr_b16 a[200:201], v17 offset:45056
    ds_read_b64_tr_b16 a[202:203], v17 offset:47104
    v_mfma_f32_32x32x16_bf16 v[176:191], a[4:7], v[36:39], v[176:191]
    buffer_load_dwordx4 v[68:71], v22, s[32:35], s14 offen offset:512 sc1
    ds_read_b64_tr_b16 a[92:93], v16 offset:46080
    ds_read_b64_tr_b16 a[94:95], v16 offset:48128
    v_mfma_f32_32x32x16_bf16 v[192:207], a[116:119], v[36:39], v[192:207]
    ds_read_b64_tr_b16 a[204:205], v17 offset:46080
    ds_read_b64_tr_b16 a[206:207], v17 offset:48128
    ds_read_b64_tr_b16 a[96:97], v16 offset:49152
    ds_read_b64_tr_b16 a[98:99], v16 offset:51200
    s_waitcnt vmcnt(8) lgkmcnt(14)
    v_mfma_f32_32x32x16_bf16 v[144:159], v[224:227], v[40:43], v[144:159]
    ds_read_b64_tr_b16 v[216:217], v18 offset:8192
    ds_read_b64_tr_b16 v[218:219], v18 offset:10240
    buffer_load_dwordx4 v[72:75], v22, s[32:35], s14 offen offset:1024 sc1
    v_mfma_f32_32x32x16_bf16 v[160:175], v[228:231], v[40:43], v[160:175]
    ds_read_b64_tr_b16 v[220:221], v19 offset:8192
    ds_read_b64_tr_b16 v[222:223], v19 offset:10240
    ds_read_b64_tr_b16 a[208:209], v17 offset:49152
    ds_read_b64_tr_b16 a[210:211], v17 offset:51200
    v_mfma_f32_32x32x16_bf16 v[176:191], a[8:11], v[40:43], v[176:191]
    buffer_load_dwordx4 v[76:79], v22, s[32:35], s14 offen offset:1536 sc1
    ds_read_b64_tr_b16 a[100:101], v16 offset:50176
    ds_read_b64_tr_b16 a[102:103], v16 offset:52224
    v_mfma_f32_32x32x16_bf16 v[192:207], a[120:123], v[40:43], v[192:207]
    ds_read_b64_tr_b16 a[212:213], v17 offset:50176
    ds_read_b64_tr_b16 a[214:215], v17 offset:52224
    ds_read_b64_tr_b16 a[104:105], v16 offset:53248
    ds_read_b64_tr_b16 a[106:107], v16 offset:55296
    s_waitcnt vmcnt(9) lgkmcnt(14)
    s_waitcnt vmcnt(6)
    v_cmp_eq_u32 vcc, s46, v24
    s_nop 0
    s_and_b32 s62, vcc_lo, s47
    s_cmp_eq_u32 s62, -1
    s_cbranch_scc0 PA_32
PD_33:
    v_mfma_f32_32x32x16_bf16 v[144:159], v[208:211], v[44:47], v[144:159]
    ds_read_b64_tr_b16 v[224:225], v18 offset:9216
    ds_read_b64_tr_b16 v[226:227], v18 offset:11264
    buffer_load_dwordx4 v[80:83], v22, s[32:35], s14 offen offset:2048 sc1
    v_mfma_f32_32x32x16_bf16 v[160:175], v[212:215], v[44:47], v[160:175]
    ds_read_b64_tr_b16 v[228:229], v19 offset:9216
    ds_read_b64_tr_b16 v[230:231], v19 offset:11264
    ds_read_b64_tr_b16 a[216:217], v17 offset:53248
    ds_read_b64_tr_b16 a[218:219], v17 offset:55296
    v_mfma_f32_32x32x16_bf16 v[176:191], a[12:15], v[44:47], v[176:191]
    buffer_load_dwordx4 v[116:119], v21, s[32:35], s15 offen offset:0 sc1
    ds_read_b64_tr_b16 a[108:109], v16 offset:54272
    ds_read_b64_tr_b16 a[110:111], v16 offset:56320
    v_mfma_f32_32x32x16_bf16 v[192:207], a[124:127], v[44:47], v[192:207]
    ds_read_b64_tr_b16 a[220:221], v17 offset:54272
    ds_read_b64_tr_b16 a[222:223], v17 offset:56320
    v_and_b32 v20, 16, v0
    v_lshl_add_u32 v23, v20, 3, v29
    s_waitcnt lgkmcnt(14)
    v_mfma_f32_32x32x16_bf16 v[144:159], v[216:219], v[48:51], v[144:159]
    ds_read_b64_tr_b16 v[208:209], v18 offset:12288
    ds_read_b64_tr_b16 v[210:211], v18 offset:14336
    buffer_load_dwordx4 v[84:87], v22, s[32:35], s14 offen offset:2560 sc1
    v_mfma_f32_32x32x16_bf16 v[160:175], v[220:223], v[48:51], v[160:175]
    ds_read_b64_tr_b16 v[212:213], v19 offset:12288
    ds_read_b64_tr_b16 v[214:215], v19 offset:14336
    s_and_b32 s65, s44, 1
    s_lshl_b32 s63, s51, 1
    v_mfma_f32_32x32x16_bf16 v[176:191], a[16:19], v[48:51], v[176:191]
    buffer_load_dwordx4 v[120:123], v21, s[32:35], s15 offen offset:512 sc1
    s_add_u32 s63, s63, s65
    s_mul_i32 s63, s63, 28672
    v_mfma_f32_32x32x16_bf16 v[192:207], a[128:131], v[48:51], v[192:207]
    s_lshl_b32 s65, s65, 8
    s_add_u32 s63, s63, s65
    s_add_u32 s63, s63, s85
    v_add_u32 v11, s63, v27
    s_waitcnt lgkmcnt(10)
    v_mfma_f32_32x32x16_bf16 v[144:159], v[224:227], v[52:55], v[144:159]
    ds_read_b64_tr_b16 v[216:217], v18 offset:13312
    ds_read_b64_tr_b16 v[218:219], v18 offset:15360
    buffer_load_dwordx4 v[88:91], v22, s[32:35], s14 offen offset:3072 sc1
    v_mfma_f32_32x32x16_bf16 v[160:175], v[228:231], v[52:55], v[160:175]
    ds_read_b64_tr_b16 v[220:221], v19 offset:13312
    ds_read_b64_tr_b16 v[222:223], v19 offset:15360
    s_mul_i32 s63, s51, -458752
    s_add_u32 s63, s63, 229376
    v_mfma_f32_32x32x16_bf16 v[176:191], a[20:23], v[52:55], v[176:191]
    buffer_load_dwordx4 v[124:127], v21, s[32:35], s15 offen offset:1024 sc1
    v_add_u32 v9, s63, v11
    v_xor_b32 v10, 256, v11
    v_mfma_f32_32x32x16_bf16 v[192:207], a[132:135], v[52:55], v[192:207]
    v_xor_b32 v8, 256, v9
    s_mov_b32 s64, -1
    s_mov_b32 s65, 0
    s_waitcnt vmcnt(11) lgkmcnt(4)
    v_mfma_f32_32x32x16_bf16 v[144:159], v[208:211], v[56:59], v[144:159]
    ds_read_b64_tr_b16 v[224:225], v18 offset:16384
    ds_read_b64_tr_b16 v[226:227], v18 offset:18432
    buffer_load_dwordx4 v[92:95], v22, s[32:35], s14 offen offset:3584 sc1
    s_add_u32 s14, s14, 4096
    v_mfma_f32_32x32x16_bf16 v[160:175], v[212:215], v[56:59], v[160:175]
    ds_read_b64_tr_b16 v[228:229], v19 offset:16384
    ds_read_b64_tr_b16 v[230:231], v19 offset:18432
    v_mfma_f32_32x32x16_bf16 v[176:191], a[24:27], v[56:59], v[176:191]
    buffer_load_dwordx4 v[128:131], v21, s[32:35], s15 offen offset:1536 sc1
    v_mfma_f32_32x32x16_bf16 v[192:207], a[136:139], v[56:59], v[192:207]
    s_waitcnt vmcnt(12) lgkmcnt(4)
    v_mfma_f32_32x32x16_bf16 v[144:159], v[216:219], v[60:63], v[144:159]
    ds_read_b64_tr_b16 v[208:209], v18 offset:17408
    ds_read_b64_tr_b16 v[210:211], v18 offset:19456
    buffer_load_dwordx4 v[132:135], v21, s[32:35], s15 offen offset:2048 sc1
    v_mfma_f32_32x32x16_bf16 v[160:175], v[220:223], v[60:63], v[160:175]
    ds_read_b64_tr_b16 v[212:213], v19 offset:17408
    ds_read_b64_tr_b16 v[214:215], v19 offset:19456
    s_waitcnt vmcnt(12) lgkmcnt(4)
    v_mfma_f32_32x32x16_bf16 v[144:159], v[224:227], v[64:67], v[144:159]
    ds_read_b64_tr_b16 v[216:217], v18 offset:20480
    ds_read_b64_tr_b16 v[218:219], v18 offset:22528
    buffer_load_dwordx4 v[136:139], v21, s[32:35], s15 offen offset:2560 sc1
    v_mfma_f32_32x32x16_bf16 v[160:175], v[228:231], v[64:67], v[160:175]
    ds_read_b64_tr_b16 v[220:221], v19 offset:20480
    ds_read_b64_tr_b16 v[222:223], v19 offset:22528
    s_waitcnt vmcnt(12) lgkmcnt(4)
    v_mfma_f32_32x32x16_bf16 v[144:159], v[208:211], v[68:71], v[144:159]
    ds_read_b64_tr_b16 v[224:225], v18 offset:21504
    ds_read_b64_tr_b16 v[226:227], v18 offset:23552
    buffer_load_dwordx4 v[140:143], v21, s[32:35], s15 offen offset:3072 sc1
    v_mfma_f32_32x32x16_bf16 v[160:175], v[212:215], v[68:71], v[160:175]
    ds_read_b64_tr_b16 v[228:229], v19 offset:21504
    ds_read_b64_tr_b16 v[230:231], v19 offset:23552
    s_waitcnt vmcnt(7)
    v_add_f32 v16, v116, v120
    s_waitcnt lgkmcnt(4)
    v_mfma_f32_32x32x16_bf16 v[144:159], v[216:219], v[72:75], v[144:159]
    ds_read_b64_tr_b16 v[208:209], v18 offset:24576
    ds_read_b64_tr_b16 v[210:211], v18 offset:26624
    buffer_load_dwordx4 v[96:99], v22, s[32:35], s14 offen offset:0 sc1
    v_mfma_f32_32x32x16_bf16 v[160:175], v[220:223], v[72:75], v[160:175]
    ds_read_b64_tr_b16 v[212:213], v19 offset:24576
    ds_read_b64_tr_b16 v[214:215], v19 offset:26624
    v_add_f32 v17, v117, v121
    v_add_f32 v25, v118, v122
    s_waitcnt lgkmcnt(4)
    v_mfma_f32_32x32x16_bf16 v[144:159], v[224:227], v[76:79], v[144:159]
    ds_read_b64_tr_b16 v[216:217], v18 offset:25600
    ds_read_b64_tr_b16 v[218:219], v18 offset:27648
    buffer_load_dwordx4 v[100:103], v22, s[32:35], s14 offen offset:512 sc1
    v_mfma_f32_32x32x16_bf16 v[160:175], v[228:231], v[76:79], v[160:175]
    ds_read_b64_tr_b16 v[220:221], v19 offset:25600
    ds_read_b64_tr_b16 v[222:223], v19 offset:27648
L_STUB4:
    s_cbranch_execz L_STUB8
    v_add_f32 v26, v119, v123
    s_waitcnt vmcnt(7)
    s_waitcnt lgkmcnt(4)
    v_mfma_f32_32x32x16_bf16 v[144:159], v[208:211], v[80:83], v[144:159]
    ds_read_b64_tr_b16 v[224:225], v18 offset:28672
    ds_read_b64_tr_b16 v[226:227], v18 offset:30720
    buffer_load_dwordx4 v[104:107], v22, s[32:35], s14 offen offset:1024 sc1
    v_mfma_f32_32x32x16_bf16 v[160:175], v[212:215], v[80:83], v[160:175]
    ds_read_b64_tr_b16 v[228:229], v19 offset:28672
    ds_read_b64_tr_b16 v[230:231], v19 offset:30720
    v_add_f32 v16, v16, v124
    v_add_f32 v17, v17, v125
    s_waitcnt lgkmcnt(4)
    v_mfma_f32_32x32x16_bf16 v[144:159], v[216:219], v[84:87], v[144:159]
    ds_read_b64_tr_b16 v[208:209], v18 offset:29696
    ds_read_b64_tr_b16 v[210:211], v18 offset:31744
    buffer_load_dwordx4 v[108:111], v22, s[32:35], s14 offen offset:1536 sc1
    v_mfma_f32_32x32x16_bf16 v[160:175], v[220:223], v[84:87], v[160:175]
    ds_read_b64_tr_b16 v[212:213], v19 offset:29696
    ds_read_b64_tr_b16 v[214:215], v19 offset:31744
    v_add_f32 v25, v25, v126
    v_add_f32 v26, v26, v127
    s_waitcnt lgkmcnt(4)
    v_mfma_f32_32x32x16_bf16 v[144:159], v[224:227], v[88:91], v[144:159]
    ds_read_b64_tr_b16 v[216:217], v18 offset:32768
    ds_read_b64_tr_b16 v[218:219], v18 offset:34816
    buffer_load_dwordx4 v[112:115], v22, s[32:35], s14 offen offset:2048 sc1
    v_mfma_f32_32x32x16_bf16 v[160:175], v[228:231], v[88:91], v[160:175]
    ds_read_b64_tr_b16 v[220:221], v19 offset:32768
    ds_read_b64_tr_b16 v[222:223], v19 offset:34816
    s_waitcnt vmcnt(8)
    v_add_f32 v16, v16, v128
    v_add_f32 v17, v17, v129
    v_mfma_f32_32x32x16_bf16 v[176:191], a[28:31], v[60:63], v[176:191]
    v_add_f32 v25, v25, v130
    v_add_f32 v26, v26, v131
    s_waitcnt vmcnt(7)
    v_add_f32 v16, v16, v132
    v_add_f32 v17, v17, v133
    s_waitcnt lgkmcnt(4)
    v_mfma_f32_32x32x16_bf16 v[144:159], v[208:211], v[92:95], v[144:159]
    ds_read_b64_tr_b16 v[224:225], v18 offset:33792
    ds_read_b64_tr_b16 v[226:227], v18 offset:35840
    buffer_load_dwordx4 v[116:119], v22, s[32:35], s14 offen offset:2560 sc1
    v_mfma_f32_32x32x16_bf16 v[160:175], v[212:215], v[92:95], v[160:175]
    ds_read_b64_tr_b16 v[228:229], v19 offset:33792
    ds_read_b64_tr_b16 v[230:231], v19 offset:35840
    v_add_f32 v25, v25, v134
    v_add_f32 v26, v26, v135
    s_waitcnt vmcnt(7)
    v_mfma_f32_32x32x16_bf16 v[176:191], a[32:35], v[64:67], v[176:191]
    v_add_f32 v16, v16, v136
    v_add_f32 v17, v17, v137
    v_add_f32 v25, v25, v138
    v_add_f32 v26, v26, v139
    s_waitcnt vmcnt(6)
    s_waitcnt vmcnt(5) lgkmcnt(4)
    v_mfma_f32_32x32x16_bf16 v[144:159], v[216:219], v[96:99], v[144:159]
    ds_read_b64_tr_b16 v[208:209], v18 offset:36864
    ds_read_b64_tr_b16 v[210:211], v18 offset:38912
    buffer_load_dwordx4 v[120:123], v22, s[32:35], s14 offen offset:3072 sc1
    v_mfma_f32_32x32x16_bf16 v[160:175], v[220:223], v[96:99], v[160:175]
    ds_read_b64_tr_b16 v[212:213], v19 offset:36864
    ds_read_b64_tr_b16 v[214:215], v19 offset:38912
    v_add_f32 v16, v16, v140
    v_add_f32 v17, v17, v141
    v_add_f32 v25, v25, v142
    v_mfma_f32_32x32x16_bf16 v[176:191], a[36:39], v[68:71], v[176:191]
    v_add_f32 v26, v26, v143
    v_mov_b32 v30, v16
    v_mov_b32 v31, v17
    v_mov_b32 v1, v25
    v_readlane_b32 s79, v26, 0
    s_waitcnt vmcnt(5) lgkmcnt(4)
    v_mfma_f32_32x32x16_bf16 v[144:159], v[224:227], v[100:103], v[144:159]
    ds_read_b64_tr_b16 v[216:217], v18 offset:37888
    ds_read_b64_tr_b16 v[218:219], v18 offset:39936
    buffer_load_dwordx4 v[124:127], v22, s[32:35], s14 offen offset:3584 sc1
    s_add_u32 s14, s14, 4096
    v_mfma_f32_32x32x16_bf16 v[160:175], v[228:231], v[100:103], v[160:175]
    ds_read_b64_tr_b16 v[220:221], v19 offset:37888
    ds_read_b64_tr_b16 v[222:223], v19 offset:39936
    v_readlane_b32 s80, v26, 1
    v_readlane_b32 s81, v26, 33
    v_readlane_b32 s82, v26, 2
    v_mfma_f32_32x32x16_bf16 v[176:191], a[40:43], v[72:75], v[176:191]
    v_readlane_b32 s83, v26, 34
    v_permlane32_swap_b32 v16, v30
    v_permlane32_swap_b32 v17, v31
    v_permlane32_swap_b32 v25, v1
    v_fma_f32 v17, -v16, v16, v17
    s_waitcnt vmcnt(5) lgkmcnt(4)
    v_mfma_f32_32x32x16_bf16 v[144:159], v[208:211], v[104:107], v[144:159]
    ds_read_b64_tr_b16 v[224:225], v18 offset:40960
    ds_read_b64_tr_b16 v[226:227], v18 offset:43008
    buffer_load_dwordx4 v[128:131], v22, s[32:35], s14 offen offset:0 sc1
    v_mfma_f32_32x32x16_bf16 v[160:175], v[212:215], v[104:107], v[160:175]
    ds_read_b64_tr_b16 v[228:229], v19 offset:40960
    ds_read_b64_tr_b16 v[230:231], v19 offset:43008
    v_fma_f32 v249, -v16, s82, v25
    v_max_f32 v17, 0, v17
    v_add_f32 v17, 0x3727c5ac, v17
    v_mfma_f32_32x32x16_bf16 v[176:191], a[44:47], v[76:79], v[176:191]
    v_sqrt_f32 v26, v17
    v_fma_f32 v252, -v16, s80, v1
    v_fma_f32 v253, v16, s79, -v31
    v_fma_f32 v249, v26, s83, v249
    s_waitcnt vmcnt(5) lgkmcnt(4)
    v_mfma_f32_32x32x16_bf16 v[144:159], v[216:219], v[108:111], v[144:159]
    ds_read_b64_tr_b16 v[208:209], v18 offset:41984
    ds_read_b64_tr_b16 v[210:211], v18 offset:44032
    buffer_load_dwordx4 v[132:135], v22, s[32:35], s14 offen offset:512 sc1
    v_mfma_f32_32x32x16_bf16 v[160:175], v[220:223], v[108:111], v[160:175]
    ds_read_b64_tr_b16 v[212:213], v19 offset:41984
    ds_read_b64_tr_b16 v[214:215], v19 offset:44032
    v_sub_f32 v253, v253, v31
    v_mul_f32 v252, v26, v252
    v_fma_f32 v250, v16, v253, v30
    v_mfma_f32_32x32x16_bf16 v[176:191], a[48:51], v[80:83], v[176:191]
    v_fma_f32 v250, v17, s81, v250
    v_fma_f32 v250, 2.0, v252, v250
    v_fma_f32 v250, -v249, v249, v250
    v_max_f32 v250, 0, v250
    v_fmac_f32 v250, 0x3727c5ac, v17
    s_waitcnt vmcnt(5) lgkmcnt(4)
    v_mfma_f32_32x32x16_bf16 v[144:159], v[224:227], v[112:115], v[144:159]
    ds_read_b64_tr_b16 v[216:217], v18 offset:45056
    ds_read_b64_tr_b16 v[218:219], v18 offset:47104
    buffer_load_dwordx4 v[136:139], v22, s[32:35], s14 offen offset:1024 sc1
    v_mfma_f32_32x32x16_bf16 v[160:175], v[228:231], v[112:115], v[160:175]
    ds_read_b64_tr_b16 v[220:221], v19 offset:45056
    ds_read_b64_tr_b16 v[222:223], v19 offset:47104
    v_sqrt_f32 v254, v250
    s_waitcnt vmcnt(5) lgkmcnt(4)
    v_mfma_f32_32x32x16_bf16 v[144:159], v[208:211], v[116:119], v[144:159]
    ds_read_b64_tr_b16 v[224:225], v18 offset:46080
    ds_read_b64_tr_b16 v[226:227], v18 offset:48128
    buffer_load_dwordx4 v[140:143], v22, s[32:35], s14 offen offset:1536 sc1
    v_mfma_f32_32x32x16_bf16 v[160:175], v[212:215], v[116:119], v[160:175]
    ds_read_b64_tr_b16 v[228:229], v19 offset:46080
    ds_read_b64_tr_b16 v[230:231], v19 offset:48128
    v_rsq_f32 v20, v250
    s_waitcnt vmcnt(5) lgkmcnt(4)
    v_mfma_f32_32x32x16_bf16 v[144:159], v[216:219], v[120:123], v[144:159]
    ds_read_b64_tr_b16 v[208:209], v18 offset:49152
    ds_read_b64_tr_b16 v[210:211], v18 offset:51200
    buffer_load_dwordx4 v[232:235], v2, s[32:35], s24 offen offset:0 sc1
    v_mfma_f32_32x32x16_bf16 v[160:175], v[220:223], v[120:123], v[160:175]
    ds_read_b64_tr_b16 v[212:213], v19 offset:49152
    ds_read_b64_tr_b16 v[214:215], v19 offset:51200
    v_cndmask_b32 v16, -v249, -v16, s[64:65]
    v_cndmask_b32 v26, v254, v26, s[64:65]
    s_waitcnt vmcnt(5) lgkmcnt(4)
    v_mfma_f32_32x32x16_bf16 v[144:159], v[224:227], v[124:127], v[144:159]
    ds_read_b64_tr_b16 v[216:217], v18 offset:50176
    ds_read_b64_tr_b16 v[218:219], v18 offset:52224
    buffer_load_dwordx4 v[236:239], v2, s[32:35], s24 offen offset:1024 sc1
    v_mfma_f32_32x32x16_bf16 v[160:175], v[228:231], v[124:127], v[160:175]
    ds_read_b64_tr_b16 v[220:221], v19 offset:50176
    ds_read_b64_tr_b16 v[222:223], v19 offset:52224
    v_mul_f32 v252, 0xc0135761, v20
    v_mul_f32 v25, v20, v20
    s_waitcnt vmcnt(5) lgkmcnt(4)
    s_barrier
    v_mfma_f32_32x32x16_bf16 v[144:159], v[208:211], v[128:131], v[144:159]
    ds_read_b64_tr_b16 v[224:225], v18 offset:53248
    ds_read_b64_tr_b16 v[226:227], v18 offset:55296
    buffer_load_dwordx4 v[240:243], v2, s[32:35], s24 offen offset:2048 sc1
    v_mfma_f32_32x32x16_bf16 v[160:175], v[212:215], v[128:131], v[160:175]
    ds_read_b64_tr_b16 v[228:229], v19 offset:53248
    ds_read_b64_tr_b16 v[230:231], v19 offset:55296
    v_mul_f32 v30, 0xbdd2d3e8, v20
    v_mul_f32 v253, v25, v30
    s_waitcnt vmcnt(5) lgkmcnt(4)
    v_mfma_f32_32x32x16_bf16 v[144:159], v[216:219], v[132:135], v[144:159]
    ds_read_b64_tr_b16 v[208:209], v18 offset:54272
    ds_read_b64_tr_b16 v[210:211], v18 offset:56320
    buffer_load_dwordx4 v[244:247], v2, s[32:35], s24 offen offset:3072 sc1
    v_mfma_f32_32x32x16_bf16 v[160:175], v[220:223], v[132:135], v[160:175]
    ds_read_b64_tr_b16 v[212:213], v19 offset:54272
    ds_read_b64_tr_b16 v[214:215], v19 offset:56320
    v_cvt_pk_bf16_f32 v248, v16, v16
    v_cvt_pk_bf16_f32 v25, v26, v26
    s_waitcnt vmcnt(5) lgkmcnt(4)
    v_mfma_f32_32x32x16_bf16 v[144:159], v[224:227], v[136:139], v[144:159]
    s_add_u32 m0, s54, 0
    s_mul_i32 s78, s70, 56
    s_add_u32 s78, s78, s77
    buffer_load_dwordx4 v4, s[20:23], s78 offen offset:0 lds
    v_and_b32 v30, 0xffff0000, v248
    v_and_b32 v25, 0xffff0000, v25
    v_mfma_f32_32x32x16_bf16 v[160:175], v[228:231], v[136:139], v[160:175]
    v_sub_f32 v16, v16, v30
    v_sub_f32 v26, v26, v25
    v_cvt_pk_bf16_f32 v249, v16, v25
    v_cvt_pk_bf16_f32 v250, v25, v26
    s_waitcnt vmcnt(5) lgkmcnt(0)
    v_mfma_f32_32x32x16_bf16 v[144:159], v[208:211], v[140:143], v[144:159]
    buffer_load_dwordx4 v5, s[20:23], s78 offen offset:1024 lds
    s_waitcnt vmcnt(2)
    v_bitop3_b32 v24, v235, v239, s40 bitop3:0x7e
    v_mfma_f32_32x32x16_bf16 v[160:175], v[212:215], v[140:143], v[160:175]
    v_bitop3_b32 v251, v243, v247, s40 bitop3:0x7e
    v_or_b32 v251, v24, v251
    v_mfma_f32_32x32x16_bf16 v[176:191], a[52:55], v[84:87], v[176:191]
    v_cmp_eq_u32 vcc, 0, v251
    s_nop 0
    s_cmp_eq_u64 vcc, -1
    s_cbranch_scc0 RC_30
RB_31:
    v_mfma_f32_32x32x16_bf16 v[144:159], v[232:235], v[248:251], v[144:159]
    s_mov_b64 exec, 1
    s_cmp_eq_u32 s47, 0
    s_cbranch_scc1 SG_34
    buffer_store_dword v3, off, s[32:35], s26 offset:1536
SR_35:
    s_mov_b64 exec, -1
    v_mfma_f32_32x32x16_bf16 v[160:175], v[236:239], v[248:251], v[160:175]
    s_barrier
    v_mfma_f32_32x32x16_bf16 v[176:191], a[56:59], v[88:91], v[176:191]
    buffer_load_dwordx4 v6, s[20:23], s78 offen offset:2048 lds
    v_mfma_f32_32x32x16_bf16 v[176:191], a[60:63], v[92:95], v[176:191]
    s_nop 1
    v_mul_f32 v208, v144, v144
    v_mul_f32 v209, v145, v145
    v_mul_f32 v210, v146, v146
    v_mul_f32 v211, v147, v147
    v_fma_f32 v208, v208, v253, v252
    v_fma_f32 v209, v209, v253, v252
    v_mfma_f32_32x32x16_bf16 v[176:191], a[64:67], v[96:99], v[176:191]
    v_fma_f32 v210, v210, v253, v252
    v_fma_f32 v211, v211, v253, v252
    v_mul_f32 v208, v208, v144
    v_mul_f32 v209, v209, v145
    v_mul_f32 v210, v210, v146
    v_mul_f32 v211, v211, v147
    v_mfma_f32_32x32x16_bf16 v[176:191], a[68:71], v[100:103], v[176:191]
    v_exp_f32 v208, v208
    v_exp_f32 v209, v209
    v_exp_f32 v210, v210
    v_mfma_f32_32x32x16_bf16 v[176:191], a[72:75], v[104:107], v[176:191]
    v_exp_f32 v211, v211
    v_mfma_f32_32x32x16_bf16 v[176:191], a[76:79], v[108:111], v[176:191]
    buffer_load_dwordx4 v7, s[20:23], s78 offen offset:3072 lds
    v_pk_fma_f32 v[208:209], v[208:209], v[254:255], v[254:255] op_sel_hi:[1,0,0]
    v_pk_fma_f32 v[210:211], v[210:211], v[254:255], v[254:255] op_sel_hi:[1,0,0]
    v_pk_mul_f32 v[212:213], v[148:149], v[148:149]
    v_pk_mul_f32 v[214:215], v[150:151], v[150:151]
    v_pk_fma_f32 v[212:213], v[212:213], v[252:253], v[252:253] op_sel:[0,1,0] op_sel_hi:[1,1,0]
    v_pk_fma_f32 v[214:215], v[214:215], v[252:253], v[252:253] op_sel:[0,1,0] op_sel_hi:[1,1,0]
    v_pk_mul_f32 v[212:213], v[212:213], v[148:149]
    v_pk_mul_f32 v[214:215], v[214:215], v[150:151]
    v_mfma_f32_32x32x16_bf16 v[176:191], a[80:83], v[112:115], v[176:191]
    v_exp_f32 v212, v212
    v_exp_f32 v213, v213
    v_exp_f32 v214, v214
    v_mfma_f32_32x32x16_bf16 v[176:191], a[84:87], v[116:119], v[176:191]
    v_exp_f32 v215, v215
    v_rcp_f32 v208, v208
    v_rcp_f32 v209, v209
    v_mfma_f32_32x32x16_bf16 v[176:191], a[88:91], v[120:123], v[176:191]
    v_rcp_f32 v210, v210
    v_rcp_f32 v211, v211
    s_add_u32 m0, s54, 16384
    s_mul_i32 s78, s71, 56
    s_add_u32 s78, s78, s77
    buffer_load_dwordx4 v4, s[20:23], s78 offen offset:0 lds
    v_pk_fma_f32 v[212:213], v[212:213], v[254:255], v[254:255] op_sel_hi:[1,0,0]
    v_pk_fma_f32 v[214:215], v[214:215], v[254:255], v[254:255] op_sel_hi:[1,0,0]
    v_pk_mul_f32 v[208:209], v[208:209], v[144:145]
    v_pk_mul_f32 v[210:211], v[210:211], v[146:147]
    v_pk_mul_f32 v[216:217], v[152:153], v[152:153]
    v_pk_mul_f32 v[218:219], v[154:155], v[154:155]
    v_pk_fma_f32 v[216:217], v[216:217], v[252:253], v[252:253] op_sel:[0,1,0] op_sel_hi:[1,1,0]
    v_pk_fma_f32 v[218:219], v[218:219], v[252:253], v[252:253] op_sel:[0,1,0] op_sel_hi:[1,1,0]
    v_pk_mul_f32 v[216:217], v[216:217], v[152:153]
    v_pk_mul_f32 v[218:219], v[218:219], v[154:155]
    v_mfma_f32_32x32x16_bf16 v[176:191], a[92:95], v[124:127], v[176:191]
    v_exp_f32 v216, v216
    v_exp_f32 v217, v217
    v_exp_f32 v218, v218
    v_mfma_f32_32x32x16_bf16 v[176:191], a[96:99], v[128:131], v[176:191]
    v_exp_f32 v219, v219
    v_rcp_f32 v212, v212
    v_rcp_f32 v213, v213
    v_mfma_f32_32x32x16_bf16 v[176:191], a[100:103], v[132:135], v[176:191]
    v_rcp_f32 v214, v214
    v_rcp_f32 v215, v215
    v_cvt_pk_bf16_f32 v224, v208, v209
    v_cvt_pk_bf16_f32 v225, v210, v211
    buffer_load_dwordx4 v5, s[20:23], s78 offen offset:1024 lds
    v_pk_fma_f32 v[216:217], v[216:217], v[254:255], v[254:255] op_sel_hi:[1,0,0]
    v_pk_fma_f32 v[218:219], v[218:219], v[254:255], v[254:255] op_sel_hi:[1,0,0]
    v_pk_mul_f32 v[212:213], v[212:213], v[148:149]
    v_pk_mul_f32 v[214:215], v[214:215], v[150:151]
    v_pk_mul_f32 v[220:221], v[156:157], v[156:157]
    v_pk_mul_f32 v[222:223], v[158:159], v[158:159]
    v_pk_fma_f32 v[220:221], v[220:221], v[252:253], v[252:253] op_sel:[0,1,0] op_sel_hi:[1,1,0]
    v_pk_fma_f32 v[222:223], v[222:223], v[252:253], v[252:253] op_sel:[0,1,0] op_sel_hi:[1,1,0]
    v_pk_mul_f32 v[220:221], v[220:221], v[156:157]
    v_pk_mul_f32 v[222:223], v[222:223], v[158:159]
    v_mfma_f32_32x32x16_bf16 v[176:191], a[104:107], v[136:139], v[176:191]
    v_exp_f32 v220, v220
    v_exp_f32 v221, v221
    v_exp_f32 v222, v222
    v_mfma_f32_32x32x16_bf16 v[176:191], a[108:111], v[140:143], v[176:191]
    v_exp_f32 v223, v223
    v_rcp_f32 v216, v216
    v_rcp_f32 v217, v217
    v_mfma_f32_32x32x16_bf16 v[176:191], v[240:243], v[248:251], v[176:191]
    v_rcp_f32 v218, v218
    v_rcp_f32 v219, v219
    v_cvt_pk_bf16_f32 v226, v212, v213
    v_cvt_pk_bf16_f32 v227, v214, v215
    buffer_store_dwordx4 v[224:227], v2, s[32:35], s25 offen offset:0
    buffer_load_dwordx4 v6, s[20:23], s78 offen offset:2048 lds
    v_pk_fma_f32 v[220:221], v[220:221], v[254:255], v[254:255] op_sel_hi:[1,0,0]
    v_pk_fma_f32 v[222:223], v[222:223], v[254:255], v[254:255] op_sel_hi:[1,0,0]
    v_pk_mul_f32 v[216:217], v[216:217], v[152:153]
    v_pk_mul_f32 v[218:219], v[218:219], v[154:155]
    v_pk_mul_f32 v[208:209], v[160:161], v[160:161]
    v_pk_mul_f32 v[210:211], v[162:163], v[162:163]
    v_pk_fma_f32 v[208:209], v[208:209], v[252:253], v[252:253] op_sel:[0,1,0] op_sel_hi:[1,1,0]
    v_pk_fma_f32 v[210:211], v[210:211], v[252:253], v[252:253] op_sel:[0,1,0] op_sel_hi:[1,1,0]
    v_pk_mul_f32 v[208:209], v[208:209], v[160:161]
    v_pk_mul_f32 v[210:211], v[210:211], v[162:163]
    v_mfma_f32_32x32x16_bf16 v[192:207], a[140:143], v[60:63], v[192:207]
    v_exp_f32 v208, v208
    v_exp_f32 v209, v209
    v_exp_f32 v210, v210
    v_mfma_f32_32x32x16_bf16 v[192:207], a[144:147], v[64:67], v[192:207]
    v_exp_f32 v211, v211
    v_rcp_f32 v220, v220
    v_rcp_f32 v221, v221
    v_mfma_f32_32x32x16_bf16 v[192:207], a[148:151], v[68:71], v[192:207]
    v_rcp_f32 v222, v222
    v_rcp_f32 v223, v223
    v_cvt_pk_bf16_f32 v228, v216, v217
    v_cvt_pk_bf16_f32 v229, v218, v219
    buffer_load_dwordx4 v7, s[20:23], s78 offen offset:3072 lds
    v_pk_fma_f32 v[208:209], v[208:209], v[254:255], v[254:255] op_sel_hi:[1,0,0]
    v_pk_fma_f32 v[210:211], v[210:211], v[254:255], v[254:255] op_sel_hi:[1,0,0]
    v_pk_mul_f32 v[220:221], v[220:221], v[156:157]
    v_pk_mul_f32 v[222:223], v[222:223], v[158:159]
    v_pk_mul_f32 v[212:213], v[164:165], v[164:165]
    v_pk_mul_f32 v[214:215], v[166:167], v[166:167]
    v_pk_fma_f32 v[212:213], v[212:213], v[252:253], v[252:253] op_sel:[0,1,0] op_sel_hi:[1,1,0]
    v_pk_fma_f32 v[214:215], v[214:215], v[252:253], v[252:253] op_sel:[0,1,0] op_sel_hi:[1,1,0]
    v_pk_mul_f32 v[212:213], v[212:213], v[164:165]
    v_pk_mul_f32 v[214:215], v[214:215], v[166:167]
    v_mfma_f32_32x32x16_bf16 v[192:207], a[152:155], v[72:75], v[192:207]
    v_exp_f32 v212, v212
    v_exp_f32 v213, v213
    v_exp_f32 v214, v214
    v_mfma_f32_32x32x16_bf16 v[192:207], a[156:159], v[76:79], v[192:207]
    v_exp_f32 v215, v215
    v_rcp_f32 v208, v208
    v_rcp_f32 v209, v209
    v_mfma_f32_32x32x16_bf16 v[192:207], a[160:163], v[80:83], v[192:207]
    v_rcp_f32 v210, v210
    v_rcp_f32 v211, v211
    v_cvt_pk_bf16_f32 v230, v220, v221
    v_cvt_pk_bf16_f32 v231, v222, v223
    buffer_store_dwordx4 v[228:231], v2, s[32:35], s25 offen offset:1024
    s_add_u32 s25, s25, 28672
    s_add_u32 m0, s54, 32768
    s_mul_i32 s78, s72, 56
    s_add_u32 s78, s78, s77
    buffer_load_dwordx4 v4, s[20:23], s78 offen offset:0 lds
    v_pk_fma_f32 v[212:213], v[212:213], v[254:255], v[254:255] op_sel_hi:[1,0,0]
    v_pk_fma_f32 v[214:215], v[214:215], v[254:255], v[254:255] op_sel_hi:[1,0,0]
    v_pk_mul_f32 v[208:209], v[208:209], v[160:161]
    v_pk_mul_f32 v[210:211], v[210:211], v[162:163]
    v_pk_mul_f32 v[216:217], v[168:169], v[168:169]
    v_pk_mul_f32 v[218:219], v[170:171], v[170:171]
    v_pk_fma_f32 v[216:217], v[216:217], v[252:253], v[252:253] op_sel:[0,1,0] op_sel_hi:[1,1,0]
    v_pk_fma_f32 v[218:219], v[218:219], v[252:253], v[252:253] op_sel:[0,1,0] op_sel_hi:[1,1,0]
    v_pk_mul_f32 v[216:217], v[216:217], v[168:169]
    v_pk_mul_f32 v[218:219], v[218:219], v[170:171]
    v_mfma_f32_32x32x16_bf16 v[192:207], a[164:167], v[84:87], v[192:207]
    v_exp_f32 v216, v216
    v_exp_f32 v217, v217
    v_exp_f32 v218, v218
    v_mfma_f32_32x32x16_bf16 v[192:207], a[168:171], v[88:91], v[192:207]
    v_exp_f32 v219, v219
    v_rcp_f32 v212, v212
    v_rcp_f32 v213, v213
    v_mfma_f32_32x32x16_bf16 v[192:207], a[172:175], v[92:95], v[192:207]
    v_rcp_f32 v214, v214
    v_rcp_f32 v215, v215
    v_cvt_pk_bf16_f32 v232, v208, v209
    v_cvt_pk_bf16_f32 v233, v210, v211
    buffer_load_dwordx4 v5, s[20:23], s78 offen offset:1024 lds
    v_pk_fma_f32 v[216:217], v[216:217], v[254:255], v[254:255] op_sel_hi:[1,0,0]
    v_pk_fma_f32 v[218:219], v[218:219], v[254:255], v[254:255] op_sel_hi:[1,0,0]
    v_pk_mul_f32 v[212:213], v[212:213], v[164:165]
    v_pk_mul_f32 v[214:215], v[214:215], v[166:167]
    v_pk_mul_f32 v[220:221], v[172:173], v[172:173]
    v_pk_mul_f32 v[222:223], v[174:175], v[174:175]
    v_pk_fma_f32 v[220:221], v[220:221], v[252:253], v[252:253] op_sel:[0,1,0] op_sel_hi:[1,1,0]
    v_pk_fma_f32 v[222:223], v[222:223], v[252:253], v[252:253] op_sel:[0,1,0] op_sel_hi:[1,1,0]
    v_pk_mul_f32 v[220:221], v[220:221], v[172:173]
    v_pk_mul_f32 v[222:223], v[222:223], v[174:175]
    v_mfma_f32_32x32x16_bf16 v[192:207], a[176:179], v[96:99], v[192:207]
    v_exp_f32 v220, v220
    v_exp_f32 v221, v221
    v_exp_f32 v222, v222
    v_mfma_f32_32x32x16_bf16 v[192:207], a[180:183], v[100:103], v[192:207]
    v_exp_f32 v223, v223
    v_rcp_f32 v216, v216
    v_rcp_f32 v217, v217
    v_mfma_f32_32x32x16_bf16 v[192:207], a[184:187], v[104:107], v[192:207]
    v_rcp_f32 v218, v218
    v_rcp_f32 v219, v219
    v_cvt_pk_bf16_f32 v234, v212, v213
    v_cvt_pk_bf16_f32 v235, v214, v215
    buffer_store_dwordx4 v[232:235], v2, s[32:35], s25 offen offset:0
    buffer_load_dword v24, v29, s[32:35], s90 offen offset:1536 sc1
    buffer_load_dwordx4 v6, s[20:23], s78 offen offset:2048 lds
    v_pk_fma_f32 v[220:221], v[220:221], v[254:255], v[254:255] op_sel_hi:[1,0,0]
    v_pk_fma_f32 v[222:223], v[222:223], v[254:255], v[254:255] op_sel_hi:[1,0,0]
    v_pk_mul_f32 v[216:217], v[216:217], v[168:169]
    v_pk_mul_f32 v[218:219], v[218:219], v[170:171]
    v_pk_mul_f32 v[208:209], v[176:177], v[176:177]
    v_pk_mul_f32 v[210:211], v[178:179], v[178:179]
    v_pk_fma_f32 v[208:209], v[208:209], v[252:253], v[252:253] op_sel:[0,1,0] op_sel_hi:[1,1,0]
    v_pk_fma_f32 v[210:211], v[210:211], v[252:253], v[252:253] op_sel:[0,1,0] op_sel_hi:[1,1,0]
    v_pk_mul_f32 v[208:209], v[208:209], v[176:177]
    v_pk_mul_f32 v[210:211], v[210:211], v[178:179]
    v_mfma_f32_32x32x16_bf16 v[192:207], a[188:191], v[108:111], v[192:207]
    v_exp_f32 v208, v208
    v_exp_f32 v209, v209
    v_exp_f32 v210, v210
    v_mfma_f32_32x32x16_bf16 v[192:207], a[192:195], v[112:115], v[192:207]
    v_exp_f32 v211, v211
    v_rcp_f32 v220, v220
    v_rcp_f32 v221, v221
    v_mfma_f32_32x32x16_bf16 v[192:207], a[196:199], v[116:119], v[192:207]
    v_rcp_f32 v222, v222
    v_rcp_f32 v223, v223
    v_cvt_pk_bf16_f32 v236, v216, v217
    v_cvt_pk_bf16_f32 v237, v218, v219
    buffer_load_dwordx4 v7, s[20:23], s78 offen offset:3072 lds
    v_pk_fma_f32 v[208:209], v[208:209], v[254:255], v[254:255] op_sel_hi:[1,0,0]
    v_pk_fma_f32 v[210:211], v[210:211], v[254:255], v[254:255] op_sel_hi:[1,0,0]
    v_pk_mul_f32 v[220:221], v[220:221], v[172:173]
    v_pk_mul_f32 v[222:223], v[222:223], v[174:175]
    v_pk_mul_f32 v[212:213], v[180:181], v[180:181]
    v_pk_mul_f32 v[214:215], v[182:183], v[182:183]
    v_pk_fma_f32 v[212:213], v[212:213], v[252:253], v[252:253] op_sel:[0,1,0] op_sel_hi:[1,1,0]
    v_pk_fma_f32 v[214:215], v[214:215], v[252:253], v[252:253] op_sel:[0,1,0] op_sel_hi:[1,1,0]
    v_pk_mul_f32 v[212:213], v[212:213], v[180:181]
    v_pk_mul_f32 v[214:215], v[214:215], v[182:183]
    v_mfma_f32_32x32x16_bf16 v[192:207], a[200:203], v[120:123], v[192:207]
    v_exp_f32 v212, v212
    v_exp_f32 v213, v213
    v_exp_f32 v214, v214
    v_mfma_f32_32x32x16_bf16 v[192:207], a[204:207], v[124:127], v[192:207]
    v_exp_f32 v215, v215
    v_rcp_f32 v208, v208
    v_rcp_f32 v209, v209
    v_mfma_f32_32x32x16_bf16 v[192:207], a[208:211], v[128:131], v[192:207]
    v_rcp_f32 v210, v210
    v_rcp_f32 v211, v211
    v_cvt_pk_bf16_f32 v238, v220, v221
    v_cvt_pk_bf16_f32 v239, v222, v223
    buffer_store_dwordx4 v[236:239], v2, s[32:35], s25 offen offset:1024
    s_add_u32 s25, s25, 28672
    s_add_u32 m0, s54, 49152
    s_mul_i32 s78, s73, 56
    s_add_u32 s78, s78, s77
    buffer_load_dwordx4 v4, s[20:23], s78 offen offset:0 lds
    v_pk_fma_f32 v[212:213], v[212:213], v[254:255], v[254:255] op_sel_hi:[1,0,0]
    v_pk_fma_f32 v[214:215], v[214:215], v[254:255], v[254:255] op_sel_hi:[1,0,0]
    v_pk_mul_f32 v[208:209], v[208:209], v[176:177]
    v_pk_mul_f32 v[210:211], v[210:211], v[178:179]
    v_pk_mul_f32 v[216:217], v[184:185], v[184:185]
    v_pk_mul_f32 v[218:219], v[186:187], v[186:187]
    v_pk_fma_f32 v[216:217], v[216:217], v[252:253], v[252:253] op_sel:[0,1,0] op_sel_hi:[1,1,0]
    v_pk_fma_f32 v[218:219], v[218:219], v[252:253], v[252:253] op_sel:[0,1,0] op_sel_hi:[1,1,0]
    v_pk_mul_f32 v[216:217], v[216:217], v[184:185]
    v_pk_mul_f32 v[218:219], v[218:219], v[186:187]
    v_mfma_f32_32x32x16_bf16 v[192:207], a[212:215], v[132:135], v[192:207]
    v_exp_f32 v216, v216
    v_exp_f32 v217, v217
    v_exp_f32 v218, v218
    v_mfma_f32_32x32x16_bf16 v[192:207], a[216:219], v[136:139], v[192:207]
    v_exp_f32 v219, v219
    v_rcp_f32 v212, v212
    v_rcp_f32 v213, v213
    v_mfma_f32_32x32x16_bf16 v[192:207], a[220:223], v[140:143], v[192:207]
    v_rcp_f32 v214, v214
    v_rcp_f32 v215, v215
    v_cvt_pk_bf16_f32 v224, v208, v209
    v_cvt_pk_bf16_f32 v225, v210, v211
    buffer_load_dwordx4 v5, s[20:23], s78 offen offset:1024 lds
    v_pk_fma_f32 v[216:217], v[216:217], v[254:255], v[254:255] op_sel_hi:[1,0,0]
    v_pk_fma_f32 v[218:219], v[218:219], v[254:255], v[254:255] op_sel_hi:[1,0,0]
    v_pk_mul_f32 v[212:213], v[212:213], v[180:181]
    v_pk_mul_f32 v[214:215], v[214:215], v[182:183]
    v_pk_mul_f32 v[220:221], v[188:189], v[188:189]
    v_pk_mul_f32 v[222:223], v[190:191], v[190:191]
    v_pk_fma_f32 v[220:221], v[220:221], v[252:253], v[252:253] op_sel:[0,1,0] op_sel_hi:[1,1,0]
    v_pk_fma_f32 v[222:223], v[222:223], v[252:253], v[252:253] op_sel:[0,1,0] op_sel_hi:[1,1,0]
    v_pk_mul_f32 v[220:221], v[220:221], v[188:189]
    v_pk_mul_f32 v[222:223], v[222:223], v[190:191]
    v_mfma_f32_32x32x16_bf16 v[192:207], v[244:247], v[248:251], v[192:207]
    v_exp_f32 v220, v220
    v_exp_f32 v221, v221
    v_exp_f32 v222, v222
    v_exp_f32 v223, v223
    v_rcp_f32 v216, v216
    v_rcp_f32 v217, v217
    v_rcp_f32 v218, v218
    v_rcp_f32_e64 v219, v219
    v_cvt_pk_bf16_f32 v226, v212, v213
    v_cvt_pk_bf16_f32 v227, v214, v215
    s_waitcnt vmcnt(5)
    v_cmp_eq_u32 vcc, s46, v24
    s_nop 0
    s_cmp_eq_u64 vcc, -1
    s_cbranch_scc0 RC_36
RB_37:
    buffer_store_dwordx4 v[224:227], v2, s[32:35], s25 offen offset:0
    buffer_load_dwordx4 v6, s[20:23], s78 offen offset:2048 lds
    v_pk_fma_f32 v[220:221], v[220:221], v[254:255], v[254:255] op_sel_hi:[1,0,0]
    v_pk_fma_f32 v[222:223], v[222:223], v[254:255], v[254:255] op_sel_hi:[1,0,0]
    v_pk_mul_f32 v[216:217], v[216:217], v[184:185]
    v_pk_mul_f32 v[218:219], v[218:219], v[186:187]
    v_pk_mul_f32 v[208:209], v[192:193], v[192:193]
    v_pk_mul_f32 v[210:211], v[194:195], v[194:195]
    v_pk_fma_f32 v[208:209], v[208:209], v[252:253], v[252:253] op_sel:[0,1,0] op_sel_hi:[1,1,0]
    v_pk_fma_f32 v[210:211], v[210:211], v[252:253], v[252:253] op_sel:[0,1,0] op_sel_hi:[1,1,0]
    v_pk_mul_f32 v[208:209], v[208:209], v[192:193]
    v_pk_mul_f32 v[210:211], v[210:211], v[194:195]
    v_exp_f32 v208, v208
    v_exp_f32 v209, v209
    v_exp_f32 v210, v210
    v_exp_f32 v211, v211
    v_rcp_f32 v220, v220
    v_rcp_f32 v221, v221
    v_rcp_f32 v222, v222
    v_rcp_f32 v223, v223
    v_cvt_pk_bf16_f32 v228, v216, v217
    v_cvt_pk_bf16_f32 v229, v218, v219
    buffer_load_dwordx4 v7, s[20:23], s78 offen offset:3072 lds
    v_pk_fma_f32 v[208:209], v[208:209], v[254:255], v[254:255] op_sel_hi:[1,0,0]
    v_pk_fma_f32 v[210:211], v[210:211], v[254:255], v[254:255] op_sel_hi:[1,0,0]
    v_pk_mul_f32 v[220:221], v[220:221], v[188:189]
    v_pk_mul_f32 v[222:223], v[222:223], v[190:191]
    v_pk_mul_f32 v[212:213], v[196:197], v[196:197]
    v_pk_mul_f32 v[214:215], v[198:199], v[198:199]
    v_pk_fma_f32 v[212:213], v[212:213], v[252:253], v[252:253] op_sel:[0,1,0] op_sel_hi:[1,1,0]
    v_pk_fma_f32 v[214:215], v[214:215], v[252:253], v[252:253] op_sel:[0,1,0] op_sel_hi:[1,1,0]
    v_pk_mul_f32 v[212:213], v[212:213], v[196:197]
    v_pk_mul_f32 v[214:215], v[214:215], v[198:199]
    v_exp_f32 v212, v212
    v_exp_f32 v213, v213
    v_exp_f32 v214, v214
    v_exp_f32 v215, v215
    v_rcp_f32 v208, v208
    v_rcp_f32 v209, v209
    v_rcp_f32 v210, v210
    v_rcp_f32 v211, v211
    v_cvt_pk_bf16_f32 v230, v220, v221
    v_cvt_pk_bf16_f32 v231, v222, v223
    buffer_store_dwordx4 v[228:231], v2, s[32:35], s25 offen offset:1024
    s_add_u32 s25, s25, 28672
    v_pk_fma_f32 v[212:213], v[212:213], v[254:255], v[254:255] op_sel_hi:[1,0,0]
    v_pk_fma_f32 v[214:215], v[214:215], v[254:255], v[254:255] op_sel_hi:[1,0,0]
    v_pk_mul_f32 v[208:209], v[208:209], v[192:193]
    v_pk_mul_f32 v[210:211], v[210:211], v[194:195]
    v_pk_mul_f32 v[216:217], v[200:201], v[200:201]
    v_pk_mul_f32 v[218:219], v[202:203], v[202:203]
    v_pk_fma_f32 v[216:217], v[216:217], v[252:253], v[252:253] op_sel:[0,1,0] op_sel_hi:[1,1,0]
    v_pk_fma_f32 v[218:219], v[218:219], v[252:253], v[252:253] op_sel:[0,1,0] op_sel_hi:[1,1,0]
    v_pk_mul_f32 v[216:217], v[216:217], v[200:201]
    v_pk_mul_f32 v[218:219], v[218:219], v[202:203]
    v_exp_f32 v216, v216
    v_exp_f32 v217, v217
    v_exp_f32 v218, v218
    v_exp_f32 v219, v219
    v_rcp_f32 v212, v212
    v_rcp_f32 v213, v213
    v_rcp_f32 v214, v214
    v_rcp_f32 v215, v215
    v_cvt_pk_bf16_f32 v232, v208, v209
    v_cvt_pk_bf16_f32 v233, v210, v211
    v_pk_fma_f32 v[216:217], v[216:217], v[254:255], v[254:255] op_sel_hi:[1,0,0]
    v_pk_fma_f32 v[218:219], v[218:219], v[254:255], v[254:255] op_sel_hi:[1,0,0]
    v_pk_mul_f32 v[212:213], v[212:213], v[196:197]
    v_pk_mul_f32 v[214:215], v[214:215], v[198:199]
    v_pk_mul_f32 v[220:221], v[204:205], v[204:205]
    v_pk_mul_f32 v[222:223], v[206:207], v[206:207]
    v_pk_fma_f32 v[220:221], v[220:221], v[252:253], v[252:253] op_sel:[0,1,0] op_sel_hi:[1,1,0]
    v_pk_fma_f32 v[222:223], v[222:223], v[252:253], v[252:253] op_sel:[0,1,0] op_sel_hi:[1,1,0]
    v_pk_mul_f32 v[220:221], v[220:221], v[204:205]
    v_pk_mul_f32 v[222:223], v[222:223], v[206:207]
    v_exp_f32 v220, v220
    v_exp_f32 v221, v221
    v_exp_f32 v222, v222
    v_exp_f32 v223, v223
    v_rcp_f32 v216, v216
    v_rcp_f32 v217, v217
    v_rcp_f32 v218, v218
    v_rcp_f32 v219, v219
    v_cvt_pk_bf16_f32 v234, v212, v213
    v_cvt_pk_bf16_f32 v235, v214, v215
    buffer_store_dwordx4 v[232:235], v2, s[32:35], s25 offen offset:0
    v_pk_fma_f32 v[220:221], v[220:221], v[254:255], v[254:255] op_sel_hi:[1,0,0]
    v_pk_fma_f32 v[222:223], v[222:223], v[254:255], v[254:255] op_sel_hi:[1,0,0]
    v_pk_mul_f32 v[216:217], v[216:217], v[200:201]
    v_pk_mul_f32 v[218:219], v[218:219], v[202:203]
    v_rcp_f32 v220, v220
    v_rcp_f32 v221, v221
    v_rcp_f32 v222, v222
    v_rcp_f32 v223, v223
    v_pk_mul_f32 v[220:221], v[220:221], v[204:205]
    v_pk_mul_f32 v[222:223], v[222:223], v[206:207]
    v_cvt_pk_bf16_f32 v236, v216, v217
    v_cvt_pk_bf16_f32 v237, v218, v219
    v_cvt_pk_bf16_f32 v238, v220, v221
    v_cvt_pk_bf16_f32 v239, v222, v223
    buffer_store_dwordx4 v[236:239], v2, s[32:35], s25 offen offset:1024
    s_waitcnt vmcnt(3)
    s_barrier
L_STUB5:
    s_cbranch_execz L_BACK
    s_and_b32 s62, s54, 4096
    v_add_u32 v240, s62, v12
    v_add_u32 v241, s62, v13
    v_add_u32 v242, s62, v14
    v_add_u32 v243, s62, v15
    s_add_u32 m0, s54, 65536
    s_mul_i32 s78, s74, 56
    s_add_u32 s78, s78, s77
    buffer_load_dwordx4 v4, s[20:23], s78 offen offset:0 lds
    ds_read_b64_tr_b16 a[0:1], v240 offset:0
    ds_read_b64_tr_b16 a[2:3], v240 offset:1024
    ds_read_b64_tr_b16 a[4:5], v241 offset:0
    ds_read_b64_tr_b16 a[6:7], v241 offset:1024
    ds_read_b64_tr_b16 a[8:9], v242 offset:0
    ds_read_b64_tr_b16 a[10:11], v242 offset:1024
    ds_read_b64_tr_b16 a[12:13], v243 offset:0
    ds_read_b64_tr_b16 a[14:15], v243 offset:1024
    buffer_load_dwordx4 v5, s[20:23], s78 offen offset:1024 lds
    ds_read_b64_tr_b16 a[16:17], v240 offset:8192
    ds_read_b64_tr_b16 a[18:19], v240 offset:9216
    ds_read_b64_tr_b16 a[20:21], v241 offset:8192
    ds_read_b64_tr_b16 a[22:23], v241 offset:9216
    ds_read_b64_tr_b16 a[24:25], v242 offset:8192
    ds_read_b64_tr_b16 a[26:27], v242 offset:9216
    ds_read_b64_tr_b16 a[28:29], v243 offset:8192
    ds_read_b64_tr_b16 a[30:31], v243 offset:9216
    buffer_load_dwordx4 v6, s[20:23], s78 offen offset:2048 lds
    ds_read_b64_tr_b16 a[32:33], v240 offset:16384
    ds_read_b64_tr_b16 a[34:35], v240 offset:17408
    ds_read_b64_tr_b16 a[36:37], v241 offset:16384
    ds_read_b64_tr_b16 a[38:39], v241 offset:17408
    ds_read_b64_tr_b16 a[40:41], v242 offset:16384
    ds_read_b64_tr_b16 a[42:43], v242 offset:17408
    ds_read_b64_tr_b16 a[44:45], v243 offset:16384
    ds_read_b64_tr_b16 a[46:47], v243 offset:17408
    buffer_load_dwordx4 v7, s[20:23], s78 offen offset:3072 lds
    ds_read_b64_tr_b16 a[48:49], v240 offset:24576
    ds_read_b64_tr_b16 a[50:51], v240 offset:25600
    ds_read_b64_tr_b16 a[52:53], v241 offset:24576
    ds_read_b64_tr_b16 a[54:55], v241 offset:25600
    ds_read_b64_tr_b16 a[56:57], v242 offset:24576
    ds_read_b64_tr_b16 a[58:59], v242 offset:25600
    ds_read_b64_tr_b16 a[60:61], v243 offset:24576
    ds_read_b64_tr_b16 a[62:63], v243 offset:25600
    s_cmp_eq_u32 s47, 0
    s_cbranch_scc1 PS_38
    s_mov_b64 exec, 1
    s_waitcnt vmcnt(4)
    buffer_store_dword v3, off, s[32:35], s27
    s_mov_b64 exec, -1
PR_39:
    v_add_u32 v244, 65536, v240
    v_add_u32 v245, 65536, v241
    v_add_u32 v246, 65536, v242
    v_add_u32 v247, 65536, v243
    v_and_b32 v22, 0x30, v0
    v_add_u32 v22, 144640, v22
    s_add_u32 m0, s54, 81920
    s_mul_i32 s78, s75, 56
    s_add_u32 s78, s78, s77
    buffer_load_dwordx4 v4, s[20:23], s78 offen offset:0 lds
    ds_read_b64_tr_b16 a[64:65], v240 offset:32768
    ds_read_b64_tr_b16 a[66:67], v240 offset:33792
    ds_read_b64_tr_b16 a[68:69], v241 offset:32768
    ds_read_b64_tr_b16 a[70:71], v241 offset:33792
    ds_read_b64_tr_b16 a[72:73], v242 offset:32768
    ds_read_b64_tr_b16 a[74:75], v242 offset:33792
    ds_read_b64_tr_b16 a[76:77], v243 offset:32768
    ds_read_b64_tr_b16 a[78:79], v243 offset:33792
    buffer_load_dwordx4 v5, s[20:23], s78 offen offset:1024 lds
    ds_read_b64_tr_b16 a[80:81], v240 offset:40960
    ds_read_b64_tr_b16 a[82:83], v240 offset:41984
    ds_read_b64_tr_b16 a[84:85], v241 offset:40960
    ds_read_b64_tr_b16 a[86:87], v241 offset:41984
    ds_read_b64_tr_b16 a[88:89], v242 offset:40960
    ds_read_b64_tr_b16 a[90:91], v242 offset:41984
    ds_read_b64_tr_b16 a[92:93], v243 offset:40960
    ds_read_b64_tr_b16 a[94:95], v243 offset:41984
    buffer_load_dwordx4 v6, s[20:23], s78 offen offset:2048 lds
    ds_read_b64_tr_b16 a[96:97], v240 offset:49152
    ds_read_b64_tr_b16 a[98:99], v240 offset:50176
    ds_read_b64_tr_b16 a[100:101], v241 offset:49152
    ds_read_b64_tr_b16 a[102:103], v241 offset:50176
    ds_read_b64_tr_b16 a[104:105], v242 offset:49152
    ds_read_b64_tr_b16 a[106:107], v242 offset:50176
    ds_read_b64_tr_b16 a[108:109], v243 offset:49152
    ds_read_b64_tr_b16 a[110:111], v243 offset:50176
    buffer_load_dwordx4 v7, s[20:23], s78 offen offset:3072 lds
    ds_read_b64_tr_b16 a[112:113], v240 offset:57344
    ds_read_b64_tr_b16 a[114:115], v240 offset:58368
    ds_read_b64_tr_b16 a[116:117], v241 offset:57344
    ds_read_b64_tr_b16 a[118:119], v241 offset:58368
    ds_read_b64_tr_b16 a[120:121], v242 offset:57344
    ds_read_b64_tr_b16 a[122:123], v242 offset:58368
    ds_read_b64_tr_b16 a[124:125], v243 offset:57344
    ds_read_b64_tr_b16 a[126:127], v243 offset:58368
    s_add_u32 m0, s54, 98304
    s_mul_i32 s78, s76, 56
    s_add_u32 s78, s78, s77
    buffer_load_dwordx4 v4, s[20:23], s78 offen offset:0 lds
    buffer_load_dwordx4 v5, s[20:23], s78 offen offset:1024 lds
    buffer_load_dwordx4 v6, s[20:23], s78 offen offset:2048 lds
    buffer_load_dwordx4 v7, s[20:23], s78 offen offset:3072 lds
    buffer_load_dword v24, v23, s[32:35], s91 offen offset:1280 sc1
    ds_read_b128 v[144:147], v22 offset:0
    ds_read_b128 v[148:151], v22 offset:64
    ds_read_b128 v[152:155], v22 offset:128
    ds_read_b128 v[156:159], v22 offset:192
    s_add_u32 s62, s54, 114688
    v_add_u32 v18, s62, v2
    v_xor_b32 v21, 4096, v18
    s_mul_i32 s62, s51, -114688
    s_add_u32 s62, s62, 57344
    s_add_u32 s79, s86, s62
    s_add_u32 s80, s79, 14336
    s_add_u32 s94, s86, 14336
    s_lshl_b32 s62, s55, 4
    s_lshl_b32 s63, s44, 2
    s_add_u32 s62, s62, s63
    s_add_u32 s82, s62, s69
    s_xor_b32 s81, s82, 16
    s_add_u32 s62, s54, 147456
    v_and_b32 v29, 15, v0
    v_mul_u32_u24 v29, 144, v29
    v_lshrrev_b32 v30, 4, v0
    v_lshl_add_u32 v29, v30, 3, v29
    v_add_u32 v19, s62, v29
    v_lshrrev_b32 v29, 3, v0
    v_mul_u32_u24 v29, 144, v29
    v_and_b32 v30, 7, v0
    v_lshl_add_u32 v29, v30, 4, v29
    v_add_u32 v20, s62, v29
    buffer_load_dword v26, v23, s[32:35], s91 offen offset:1280 sc1
    s_waitcnt vmcnt(1)
    s_barrier
    v_cmp_eq_u32 vcc, s46, v24
    s_nop 0
    s_and_b32 s62, vcc_lo, s47
    s_cmp_eq_u32 s62, -1
    s_cbranch_scc0 PA_40
PD_41:
    buffer_load_dwordx4 v[32:35], v8, s[32:35], s70 offen offset:0 sc1
    ds_read_b64_tr_b16 a[128:129], v244 offset:0
    ds_read_b64_tr_b16 a[130:131], v244 offset:1024
    ds_read_b64_tr_b16 a[132:133], v245 offset:0
    ds_read_b64_tr_b16 a[134:135], v245 offset:1024
    ds_read_b64_tr_b16 a[136:137], v246 offset:0
    buffer_load_dwordx4 v[36:39], v8, s[32:35], s70 offen offset:2048 sc1
    ds_read_b64_tr_b16 a[138:139], v246 offset:1024
    ds_read_b64_tr_b16 a[140:141], v247 offset:0
    ds_read_b64_tr_b16 a[142:143], v247 offset:1024
    ds_read_b64_tr_b16 a[144:145], v244 offset:8192
    ds_read_b64_tr_b16 a[146:147], v244 offset:9216
    buffer_load_dwordx4 v[40:43], v8, s[32:35], s71 offen offset:0 sc1
    ds_read_b64_tr_b16 a[148:149], v245 offset:8192
    ds_read_b64_tr_b16 a[150:151], v245 offset:9216
    ds_read_b64_tr_b16 a[152:153], v246 offset:8192
    ds_read_b64_tr_b16 a[154:155], v246 offset:9216
    ds_read_b64_tr_b16 a[156:157], v247 offset:8192
    buffer_load_dwordx4 v[44:47], v8, s[32:35], s71 offen offset:2048 sc1
    ds_read_b64_tr_b16 a[158:159], v247 offset:9216
    ds_read_b64_tr_b16 a[160:161], v244 offset:16384
    ds_read_b64_tr_b16 a[162:163], v244 offset:17408
    ds_read_b64_tr_b16 a[164:165], v245 offset:16384
    ds_read_b64_tr_b16 a[166:167], v245 offset:17408
    buffer_load_dwordx4 v[48:51], v8, s[32:35], s72 offen offset:0 sc1
    ds_read_b64_tr_b16 a[168:169], v246 offset:16384
    ds_read_b64_tr_b16 a[170:171], v246 offset:17408
    ds_read_b64_tr_b16 a[172:173], v247 offset:16384
    ds_read_b64_tr_b16 a[174:175], v247 offset:17408
    ds_read_b64_tr_b16 a[176:177], v244 offset:24576
    buffer_load_dwordx4 v[52:55], v8, s[32:35], s72 offen offset:2048 sc1
    ds_read_b64_tr_b16 a[178:179], v244 offset:25600
    ds_read_b64_tr_b16 a[180:181], v245 offset:24576
    ds_read_b64_tr_b16 a[182:183], v245 offset:25600
    ds_read_b64_tr_b16 a[184:185], v246 offset:24576
    ds_read_b64_tr_b16 a[186:187], v246 offset:25600
    buffer_load_dwordx4 v[56:59], v8, s[32:35], s73 offen offset:0 sc1
    ds_read_b64_tr_b16 a[188:189], v247 offset:24576
    ds_read_b64_tr_b16 a[190:191], v247 offset:25600
    ds_read_b64_tr_b16 a[192:193], v244 offset:32768
    ds_read_b64_tr_b16 a[194:195], v244 offset:33792
    ds_read_b64_tr_b16 a[196:197], v245 offset:32768
    ds_read_b64_tr_b16 a[198:199], v245 offset:33792
    ds_read_b64_tr_b16 a[200:201], v246 offset:32768
    ds_read_b64_tr_b16 a[202:203], v246 offset:33792
    ds_read_b64_tr_b16 a[204:205], v247 offset:32768
    ds_read_b64_tr_b16 a[206:207], v247 offset:33792
    ds_read_b64_tr_b16 a[208:209], v244 offset:40960
    ds_read_b64_tr_b16 a[210:211], v244 offset:41984
    ds_read_b64_tr_b16 a[212:213], v245 offset:40960
    ds_read_b64_tr_b16 a[214:215], v245 offset:41984
    ds_read_b64_tr_b16 a[216:217], v246 offset:40960
    ds_read_b64_tr_b16 a[218:219], v246 offset:41984
    ds_read_b64_tr_b16 a[220:221], v247 offset:40960
    ds_read_b64_tr_b16 a[222:223], v247 offset:41984
    s_waitcnt vmcnt(6) lgkmcnt(0)
    v_mfma_f32_16x16x32_bf16 v[160:163], a[0:3], v[32:35], 0
    buffer_load_dwordx4 v[60:63], v8, s[32:35], s73 offen offset:2048 sc1
    v_mfma_f32_16x16x32_bf16 v[164:167], a[4:7], v[32:35], 0
    v_mfma_f32_16x16x32_bf16 v[168:171], a[8:11], v[32:35], 0
    v_mfma_f32_16x16x32_bf16 v[172:175], a[12:15], v[32:35], 0
    s_waitcnt vmcnt(6)
    v_mfma_f32_16x16x32_bf16 v[160:163], a[16:19], v[36:39], v[160:163]
    buffer_load_dwordx4 v[64:67], v8, s[32:35], s74 offen offset:0 sc1
    v_mfma_f32_16x16x32_bf16 v[164:167], a[20:23], v[36:39], v[164:167]
    v_mfma_f32_16x16x32_bf16 v[168:171], a[24:27], v[36:39], v[168:171]
    v_mfma_f32_16x16x32_bf16 v[172:175], a[28:31], v[36:39], v[172:175]
    s_waitcnt vmcnt(6)
    v_mfma_f32_16x16x32_bf16 v[160:163], a[32:35], v[40:43], v[160:163]
    buffer_load_dwordx4 v[68:71], v8, s[32:35], s74 offen offset:2048 sc1
    v_mfma_f32_16x16x32_bf16 v[164:167], a[36:39], v[40:43], v[164:167]
    v_mfma_f32_16x16x32_bf16 v[168:171], a[40:43], v[40:43], v[168:171]
    v_mfma_f32_16x16x32_bf16 v[172:175], a[44:47], v[40:43], v[172:175]
    s_waitcnt vmcnt(6)
    v_mfma_f32_16x16x32_bf16 v[160:163], a[48:51], v[44:47], v[160:163]
    buffer_load_dwordx4 v[72:75], v8, s[32:35], s75 offen offset:0 sc1
    v_mfma_f32_16x16x32_bf16 v[164:167], a[52:55], v[44:47], v[164:167]
    v_mfma_f32_16x16x32_bf16 v[168:171], a[56:59], v[44:47], v[168:171]
    v_mfma_f32_16x16x32_bf16 v[172:175], a[60:63], v[44:47], v[172:175]
    s_waitcnt vmcnt(6)
    v_mfma_f32_16x16x32_bf16 v[160:163], a[64:67], v[48:51], v[160:163]
    buffer_load_dwordx4 v[76:79], v8, s[32:35], s75 offen offset:2048 sc1
    v_mfma_f32_16x16x32_bf16 v[164:167], a[68:71], v[48:51], v[164:167]
    v_mfma_f32_16x16x32_bf16 v[168:171], a[72:75], v[48:51], v[168:171]
    v_mfma_f32_16x16x32_bf16 v[172:175], a[76:79], v[48:51], v[172:175]
    s_waitcnt vmcnt(6)
    v_mfma_f32_16x16x32_bf16 v[160:163], a[80:83], v[52:55], v[160:163]
    buffer_load_dwordx4 v[80:83], v8, s[32:35], s76 offen offset:0 sc1
    v_mfma_f32_16x16x32_bf16 v[164:167], a[84:87], v[52:55], v[164:167]
    v_mfma_f32_16x16x32_bf16 v[168:171], a[88:91], v[52:55], v[168:171]
    v_mfma_f32_16x16x32_bf16 v[172:175], a[92:95], v[52:55], v[172:175]
    s_waitcnt vmcnt(6)
    v_mfma_f32_16x16x32_bf16 v[160:163], a[96:99], v[56:59], v[160:163]
    buffer_load_dwordx4 v[84:87], v8, s[32:35], s76 offen offset:2048 sc1
    v_mfma_f32_16x16x32_bf16 v[164:167], a[100:103], v[56:59], v[164:167]
    v_mfma_f32_16x16x32_bf16 v[168:171], a[104:107], v[56:59], v[168:171]
    v_mfma_f32_16x16x32_bf16 v[172:175], a[108:111], v[56:59], v[172:175]
    s_waitcnt vmcnt(6)
    v_mfma_f32_16x16x32_bf16 v[160:163], a[112:115], v[60:63], v[160:163]
    buffer_load_dwordx4 v[88:91], v9, s[32:35], s70 offen offset:0 sc1
    v_mfma_f32_16x16x32_bf16 v[164:167], a[116:119], v[60:63], v[164:167]
    v_mfma_f32_16x16x32_bf16 v[168:171], a[120:123], v[60:63], v[168:171]
    v_mfma_f32_16x16x32_bf16 v[172:175], a[124:127], v[60:63], v[172:175]
    s_waitcnt vmcnt(6)
    v_mfma_f32_16x16x32_bf16 v[160:163], a[128:131], v[64:67], v[160:163]
    buffer_load_dwordx4 v[92:95], v9, s[32:35], s70 offen offset:2048 sc1
    v_mfma_f32_16x16x32_bf16 v[164:167], a[132:135], v[64:67], v[164:167]
    v_mfma_f32_16x16x32_bf16 v[168:171], a[136:139], v[64:67], v[168:171]
    v_mfma_f32_16x16x32_bf16 v[172:175], a[140:143], v[64:67], v[172:175]
    s_waitcnt vmcnt(6)
    v_mfma_f32_16x16x32_bf16 v[160:163], a[144:147], v[68:71], v[160:163]
    buffer_load_dwordx4 v[96:99], v9, s[32:35], s71 offen offset:0 sc1
    v_mfma_f32_16x16x32_bf16 v[164:167], a[148:151], v[68:71], v[164:167]
    v_mfma_f32_16x16x32_bf16 v[168:171], a[152:155], v[68:71], v[168:171]
    v_mfma_f32_16x16x32_bf16 v[172:175], a[156:159], v[68:71], v[172:175]
    s_waitcnt vmcnt(6)
    v_mfma_f32_16x16x32_bf16 v[160:163], a[160:163], v[72:75], v[160:163]
    buffer_load_dwordx4 v[100:103], v9, s[32:35], s71 offen offset:2048 sc1
    v_mfma_f32_16x16x32_bf16 v[164:167], a[164:167], v[72:75], v[164:167]
    v_mfma_f32_16x16x32_bf16 v[168:171], a[168:171], v[72:75], v[168:171]
    v_mfma_f32_16x16x32_bf16 v[172:175], a[172:175], v[72:75], v[172:175]
    s_waitcnt vmcnt(6)
    v_mfma_f32_16x16x32_bf16 v[160:163], a[176:179], v[76:79], v[160:163]
    buffer_load_dwordx4 v[104:107], v9, s[32:35], s72 offen offset:0 sc1
    v_mfma_f32_16x16x32_bf16 v[164:167], a[180:183], v[76:79], v[164:167]
    v_mfma_f32_16x16x32_bf16 v[168:171], a[184:187], v[76:79], v[168:171]
    v_mfma_f32_16x16x32_bf16 v[172:175], a[188:191], v[76:79], v[172:175]
    s_waitcnt vmcnt(6)
    v_mfma_f32_16x16x32_bf16 v[160:163], a[192:195], v[80:83], v[160:163]
    buffer_load_dwordx4 v[108:111], v9, s[32:35], s72 offen offset:2048 sc1
    v_mfma_f32_16x16x32_bf16 v[164:167], a[196:199], v[80:83], v[164:167]
    v_mfma_f32_16x16x32_bf16 v[168:171], a[200:203], v[80:83], v[168:171]
    v_mfma_f32_16x16x32_bf16 v[172:175], a[204:207], v[80:83], v[172:175]
    s_waitcnt vmcnt(6)
    v_mfma_f32_16x16x32_bf16 v[160:163], a[208:211], v[84:87], v[160:163]
    buffer_load_dwordx4 v[112:115], v9, s[32:35], s73 offen offset:0 sc1
    v_mfma_f32_16x16x32_bf16 v[164:167], a[212:215], v[84:87], v[164:167]
    v_mfma_f32_16x16x32_bf16 v[168:171], a[216:219], v[84:87], v[168:171]
    v_mfma_f32_16x16x32_bf16 v[172:175], a[220:223], v[84:87], v[172:175]
    s_waitcnt vmcnt(6)
    v_mfma_f32_16x16x32_bf16 v[176:179], a[0:3], v[88:91], 0
    buffer_load_dwordx4 v[116:119], v9, s[32:35], s73 offen offset:2048 sc1
    v_mfma_f32_16x16x32_bf16 v[180:183], a[4:7], v[88:91], 0
    v_mfma_f32_16x16x32_bf16 v[184:187], a[8:11], v[88:91], 0
    v_mfma_f32_16x16x32_bf16 v[188:191], a[12:15], v[88:91], 0
    s_waitcnt vmcnt(6)
    v_mfma_f32_16x16x32_bf16 v[176:179], a[16:19], v[92:95], v[176:179]
    buffer_load_dwordx4 v[120:123], v9, s[32:35], s74 offen offset:0 sc1
    v_mfma_f32_16x16x32_bf16 v[180:183], a[20:23], v[92:95], v[180:183]
    v_mfma_f32_16x16x32_bf16 v[184:187], a[24:27], v[92:95], v[184:187]
    v_mfma_f32_16x16x32_bf16 v[188:191], a[28:31], v[92:95], v[188:191]
    s_waitcnt vmcnt(6)
    v_mfma_f32_16x16x32_bf16 v[176:179], a[32:35], v[96:99], v[176:179]
    buffer_load_dwordx4 v[124:127], v9, s[32:35], s74 offen offset:2048 sc1
    v_mfma_f32_16x16x32_bf16 v[180:183], a[36:39], v[96:99], v[180:183]
    ds_write_b128 v18, v[160:163] offset:0
    v_mfma_f32_16x16x32_bf16 v[184:187], a[40:43], v[96:99], v[184:187]
    v_accvgpr_read_b32 v128, a224
    v_mfma_f32_16x16x32_bf16 v[188:191], a[44:47], v[96:99], v[188:191]
    s_waitcnt vmcnt(6)
    v_mfma_f32_16x16x32_bf16 v[176:179], a[48:51], v[100:103], v[176:179]
    buffer_load_dwordx4 v[32:35], v9, s[32:35], s75 offen offset:0 sc1
    v_mfma_f32_16x16x32_bf16 v[180:183], a[52:55], v[100:103], v[180:183]
    ds_write_b128 v18, v[164:167] offset:1024
    v_mfma_f32_16x16x32_bf16 v[184:187], a[56:59], v[100:103], v[184:187]
    v_accvgpr_read_b32 v129, a225
    v_mfma_f32_16x16x32_bf16 v[188:191], a[60:63], v[100:103], v[188:191]
    s_waitcnt vmcnt(6)
    v_mfma_f32_16x16x32_bf16 v[176:179], a[64:67], v[104:107], v[176:179]
    buffer_load_dwordx4 v[36:39], v9, s[32:35], s75 offen offset:2048 sc1
    v_mfma_f32_16x16x32_bf16 v[180:183], a[68:71], v[104:107], v[180:183]
    ds_write_b128 v18, v[168:171] offset:2048
    v_mfma_f32_16x16x32_bf16 v[184:187], a[72:75], v[104:107], v[184:187]
    v_accvgpr_read_b32 v130, a226
    v_mfma_f32_16x16x32_bf16 v[188:191], a[76:79], v[104:107], v[188:191]
    s_waitcnt vmcnt(6)
    v_mfma_f32_16x16x32_bf16 v[176:179], a[80:83], v[108:111], v[176:179]
    buffer_load_dwordx4 v[40:43], v9, s[32:35], s76 offen offset:0 sc1
    v_mfma_f32_16x16x32_bf16 v[180:183], a[84:87], v[108:111], v[180:183]
    ds_write_b128 v18, v[172:175] offset:3072
    v_mfma_f32_16x16x32_bf16 v[184:187], a[88:91], v[108:111], v[184:187]
    v_accvgpr_read_b32 v131, a227
    v_mfma_f32_16x16x32_bf16 v[188:191], a[92:95], v[108:111], v[188:191]
    s_waitcnt vmcnt(6)
    v_mfma_f32_16x16x32_bf16 v[176:179], a[96:99], v[112:115], v[176:179]
    buffer_load_dwordx4 v[44:47], v9, s[32:35], s76 offen offset:2048 sc1
    v_mfma_f32_16x16x32_bf16 v[180:183], a[100:103], v[112:115], v[180:183]
    v_accvgpr_read_b32 v132, a228
    v_mfma_f32_16x16x32_bf16 v[184:187], a[104:107], v[112:115], v[184:187]
    v_accvgpr_read_b32 v133, a229
    v_mfma_f32_16x16x32_bf16 v[188:191], a[108:111], v[112:115], v[188:191]
    s_waitcnt vmcnt(6)
    v_mfma_f32_16x16x32_bf16 v[176:179], a[112:115], v[116:119], v[176:179]
    buffer_load_dwordx4 v[48:51], v10, s[32:35], s70 offen offset:0 sc1
    v_mfma_f32_16x16x32_bf16 v[180:183], a[116:119], v[116:119], v[180:183]
    v_accvgpr_read_b32 v134, a230
    v_mfma_f32_16x16x32_bf16 v[184:187], a[120:123], v[116:119], v[184:187]
    v_accvgpr_read_b32 v135, a231
    v_mfma_f32_16x16x32_bf16 v[188:191], a[124:127], v[116:119], v[188:191]
    s_waitcnt vmcnt(6)
    v_mfma_f32_16x16x32_bf16 v[176:179], a[128:131], v[120:123], v[176:179]
    buffer_load_dwordx4 v[52:55], v10, s[32:35], s70 offen offset:2048 sc1
    v_mfma_f32_16x16x32_bf16 v[180:183], a[132:135], v[120:123], v[180:183]
    s_waitcnt lgkmcnt(0)
    s_barrier
    v_mfma_f32_16x16x32_bf16 v[184:187], a[136:139], v[120:123], v[184:187]
    ds_read_b128 v[192:195], v21 offset:0
    v_mfma_f32_16x16x32_bf16 v[188:191], a[140:143], v[120:123], v[188:191]
    s_waitcnt vmcnt(6)
    v_mfma_f32_16x16x32_bf16 v[176:179], a[144:147], v[124:127], v[176:179]
    buffer_load_dwordx4 v[56:59], v10, s[32:35], s71 offen offset:0 sc1
    v_mfma_f32_16x16x32_bf16 v[180:183], a[148:151], v[124:127], v[180:183]
    ds_read_b128 v[196:199], v21 offset:1024
    v_mfma_f32_16x16x32_bf16 v[184:187], a[152:155], v[124:127], v[184:187]
    ds_read_b128 v[200:203], v21 offset:2048
    v_mfma_f32_16x16x32_bf16 v[188:191], a[156:159], v[124:127], v[188:191]
    s_waitcnt vmcnt(6)
    v_mfma_f32_16x16x32_bf16 v[176:179], a[160:163], v[32:35], v[176:179]
    buffer_load_dwordx4 v[60:63], v10, s[32:35], s71 offen offset:2048 sc1
    v_mfma_f32_16x16x32_bf16 v[180:183], a[164:167], v[32:35], v[180:183]
    ds_read_b128 v[204:207], v21 offset:3072
    v_mfma_f32_16x16x32_bf16 v[184:187], a[168:171], v[32:35], v[184:187]
    v_accvgpr_read_b32 v136, a232
    v_mfma_f32_16x16x32_bf16 v[188:191], a[172:175], v[32:35], v[188:191]
    s_waitcnt vmcnt(6)
    v_mfma_f32_16x16x32_bf16 v[176:179], a[176:179], v[36:39], v[176:179]
    buffer_load_dwordx4 v[64:67], v10, s[32:35], s72 offen offset:0 sc1
    v_mfma_f32_16x16x32_bf16 v[180:183], a[180:183], v[36:39], v[180:183]
    v_accvgpr_read_b32 v137, a233
    v_mfma_f32_16x16x32_bf16 v[184:187], a[184:187], v[36:39], v[184:187]
    v_accvgpr_read_b32 v138, a234
    v_mfma_f32_16x16x32_bf16 v[188:191], a[188:191], v[36:39], v[188:191]
    s_waitcnt vmcnt(6)
    v_mfma_f32_16x16x32_bf16 v[176:179], a[192:195], v[40:43], v[176:179]
    buffer_load_dwordx4 v[68:71], v10, s[32:35], s72 offen offset:2048 sc1
    v_mfma_f32_16x16x32_bf16 v[180:183], a[196:199], v[40:43], v[180:183]
    v_accvgpr_read_b32 v139, a235
    v_mfma_f32_16x16x32_bf16 v[184:187], a[200:203], v[40:43], v[184:187]
    v_accvgpr_read_b32 v140, a236
    v_mfma_f32_16x16x32_bf16 v[188:191], a[204:207], v[40:43], v[188:191]
    s_waitcnt vmcnt(6)
    v_mfma_f32_16x16x32_bf16 v[176:179], a[208:211], v[44:47], v[176:179]
    buffer_load_dwordx4 v[72:75], v10, s[32:35], s73 offen offset:0 sc1
    v_mfma_f32_16x16x32_bf16 v[180:183], a[212:215], v[44:47], v[180:183]
    v_accvgpr_read_b32 v141, a237
    v_mfma_f32_16x16x32_bf16 v[184:187], a[216:219], v[44:47], v[184:187]
    v_accvgpr_read_b32 v142, a238
    v_mfma_f32_16x16x32_bf16 v[188:191], a[220:223], v[44:47], v[188:191]
    s_waitcnt vmcnt(6)
    v_mfma_f32_16x16x32_bf16 v[160:163], a[0:3], v[48:51], 0
    buffer_load_dwordx4 v[76:79], v10, s[32:35], s73 offen offset:2048 sc1
    v_mfma_f32_16x16x32_bf16 v[164:167], a[4:7], v[48:51], 0
    v_accvgpr_read_b32 v143, a239
    v_mfma_f32_16x16x32_bf16 v[168:171], a[8:11], v[48:51], 0
    v_mfma_f32_16x16x32_bf16 v[172:175], a[12:15], v[48:51], 0
    s_waitcnt vmcnt(6)
    v_mfma_f32_16x16x32_bf16 v[160:163], a[16:19], v[52:55], v[160:163]
    buffer_load_dwordx4 v[80:83], v10, s[32:35], s74 offen offset:0 sc1
    v_mfma_f32_16x16x32_bf16 v[164:167], a[20:23], v[52:55], v[164:167]
    s_waitcnt lgkmcnt(0)
    v_mfma_f32_16x16x32_bf16 v[168:171], a[24:27], v[52:55], v[168:171]
    v_add_f32 v192, v192, v176
    v_add_f32 v193, v193, v177
    v_add_f32 v194, v194, v178
    v_mfma_f32_16x16x32_bf16 v[172:175], a[28:31], v[52:55], v[172:175]
    s_waitcnt vmcnt(6)
    v_add_f32 v195, v195, v179
    v_add_f32 v196, v196, v180
    v_add_f32 v197, v197, v181
    v_mfma_f32_16x16x32_bf16 v[160:163], a[32:35], v[56:59], v[160:163]
    buffer_load_dwordx4 v[84:87], v10, s[32:35], s74 offen offset:2048 sc1
    v_mfma_f32_16x16x32_bf16 v[164:167], a[36:39], v[56:59], v[164:167]
    v_add_f32 v198, v198, v182
    v_add_f32 v199, v199, v183
    v_cvt_pk_bf16_f32 v232, v192, v193
    v_mfma_f32_16x16x32_bf16 v[168:171], a[40:43], v[56:59], v[168:171]
    v_cvt_pk_bf16_f32 v233, v194, v195
    v_cvt_pk_bf16_f32 v234, v196, v197
    v_cvt_pk_bf16_f32 v235, v198, v199
    v_mfma_f32_16x16x32_bf16 v[172:175], a[44:47], v[56:59], v[172:175]
    s_waitcnt vmcnt(6)
    buffer_store_dwordx4 v[232:235], v28, s[28:31], s79 offen
    v_mfma_f32_16x16x32_bf16 v[160:163], a[48:51], v[60:63], v[160:163]
    buffer_load_dwordx4 v[88:91], v10, s[32:35], s75 offen offset:0 sc1
    v_mfma_f32_16x16x32_bf16 v[164:167], a[52:55], v[60:63], v[164:167]
    v_add_f32 v200, v200, v184
    v_add_f32 v201, v201, v185
    v_add_f32 v202, v202, v186
    v_mfma_f32_16x16x32_bf16 v[168:171], a[56:59], v[60:63], v[168:171]
    v_add_f32 v203, v203, v187
    v_add_f32 v204, v204, v188
    v_add_f32 v205, v205, v189
    v_mfma_f32_16x16x32_bf16 v[172:175], a[60:63], v[60:63], v[172:175]
    s_waitcnt vmcnt(7)
    v_add_f32 v206, v206, v190
    v_add_f32 v207, v207, v191
    v_cvt_pk_bf16_f32 v236, v200, v201
    v_mfma_f32_16x16x32_bf16 v[160:163], a[64:67], v[64:67], v[160:163]
    buffer_load_dwordx4 v[92:95], v10, s[32:35], s75 offen offset:2048 sc1
    v_mfma_f32_16x16x32_bf16 v[164:167], a[68:71], v[64:67], v[164:167]
    v_cvt_pk_bf16_f32 v237, v202, v203
    v_cvt_pk_bf16_f32 v238, v204, v205
    v_cvt_pk_bf16_f32 v239, v206, v207
    v_mfma_f32_16x16x32_bf16 v[168:171], a[72:75], v[64:67], v[168:171]
    buffer_store_dwordx4 v[236:239], v28, s[28:31], s80 offen
    v_mfma_f32_16x16x32_bf16 v[172:175], a[76:79], v[64:67], v[172:175]
    s_waitcnt vmcnt(8)
    v_mfma_f32_16x16x32_bf16 v[160:163], a[80:83], v[68:71], v[160:163]
    buffer_load_dwordx4 v[96:99], v10, s[32:35], s76 offen offset:0 sc1
    v_mfma_f32_16x16x32_bf16 v[164:167], a[84:87], v[68:71], v[164:167]
    v_mfma_f32_16x16x32_bf16 v[168:171], a[88:91], v[68:71], v[168:171]
    v_mfma_f32_16x16x32_bf16 v[172:175], a[92:95], v[68:71], v[172:175]
    s_waitcnt vmcnt(8)
    v_mfma_f32_16x16x32_bf16 v[160:163], a[96:99], v[72:75], v[160:163]
    buffer_load_dwordx4 v[100:103], v10, s[32:35], s76 offen offset:2048 sc1
    v_mfma_f32_16x16x32_bf16 v[164:167], a[100:103], v[72:75], v[164:167]
    v_mfma_f32_16x16x32_bf16 v[168:171], a[104:107], v[72:75], v[168:171]
    v_mfma_f32_16x16x32_bf16 v[172:175], a[108:111], v[72:75], v[172:175]
    s_waitcnt vmcnt(8)
    v_mfma_f32_16x16x32_bf16 v[160:163], a[112:115], v[76:79], v[160:163]
    buffer_load_dwordx4 v[104:107], v11, s[32:35], s70 offen offset:0 sc1
    v_mfma_f32_16x16x32_bf16 v[164:167], a[116:119], v[76:79], v[164:167]
    v_mfma_f32_16x16x32_bf16 v[168:171], a[120:123], v[76:79], v[168:171]
    v_mfma_f32_16x16x32_bf16 v[172:175], a[124:127], v[76:79], v[172:175]
    s_waitcnt vmcnt(8)
    v_mfma_f32_16x16x32_bf16 v[160:163], a[128:131], v[80:83], v[160:163]
    buffer_load_dwordx4 v[108:111], v11, s[32:35], s70 offen offset:2048 sc1
    v_mfma_f32_16x16x32_bf16 v[164:167], a[132:135], v[80:83], v[164:167]
    v_mfma_f32_16x16x32_bf16 v[168:171], a[136:139], v[80:83], v[168:171]
    v_mfma_f32_16x16x32_bf16 v[172:175], a[140:143], v[80:83], v[172:175]
    s_waitcnt vmcnt(8)
    v_mfma_f32_16x16x32_bf16 v[160:163], a[144:147], v[84:87], v[160:163]
    buffer_load_dwordx4 v[112:115], v11, s[32:35], s71 offen offset:0 sc1
    v_mfma_f32_16x16x32_bf16 v[164:167], a[148:151], v[84:87], v[164:167]
    v_mfma_f32_16x16x32_bf16 v[168:171], a[152:155], v[84:87], v[168:171]
    v_mfma_f32_16x16x32_bf16 v[172:175], a[156:159], v[84:87], v[172:175]
    s_waitcnt vmcnt(7)
    v_mfma_f32_16x16x32_bf16 v[160:163], a[160:163], v[88:91], v[160:163]
    buffer_load_dwordx4 v[116:119], v11, s[32:35], s71 offen offset:2048 sc1
    v_mfma_f32_16x16x32_bf16 v[164:167], a[164:167], v[88:91], v[164:167]
    s_cmp_eq_u32 s47, 0
    s_cbranch_scc1 PS_42
    s_mov_b64 exec, 1
    s_waitcnt vmcnt(6)
    buffer_store_dword v3, off, s[32:35], s81 offset:2560
    s_mov_b64 exec, -1
PR_43:
    v_mfma_f32_16x16x32_bf16 v[168:171], a[168:171], v[88:91], v[168:171]
    v_mfma_f32_16x16x32_bf16 v[172:175], a[172:175], v[88:91], v[172:175]
    v_mfma_f32_16x16x32_bf16 v[160:163], a[176:179], v[92:95], v[160:163]
    buffer_load_dwordx4 v[120:123], v11, s[32:35], s72 offen offset:0 sc1
    v_mfma_f32_16x16x32_bf16 v[164:167], a[180:183], v[92:95], v[164:167]
    v_mfma_f32_16x16x32_bf16 v[168:171], a[184:187], v[92:95], v[168:171]
    v_mfma_f32_16x16x32_bf16 v[172:175], a[188:191], v[92:95], v[172:175]
    s_waitcnt vmcnt(7)
    v_mfma_f32_16x16x32_bf16 v[160:163], a[192:195], v[96:99], v[160:163]
    buffer_load_dwordx4 v[124:127], v11, s[32:35], s72 offen offset:2048 sc1
    v_mfma_f32_16x16x32_bf16 v[164:167], a[196:199], v[96:99], v[164:167]
    v_mfma_f32_16x16x32_bf16 v[168:171], a[200:203], v[96:99], v[168:171]
    v_mfma_f32_16x16x32_bf16 v[172:175], a[204:207], v[96:99], v[172:175]
    s_waitcnt vmcnt(7)
    v_mfma_f32_16x16x32_bf16 v[160:163], a[208:211], v[100:103], v[160:163]
    buffer_load_dwordx4 v[32:35], v11, s[32:35], s73 offen offset:0 sc1
    v_mfma_f32_16x16x32_bf16 v[164:167], a[212:215], v[100:103], v[164:167]
    v_mfma_f32_16x16x32_bf16 v[168:171], a[216:219], v[100:103], v[168:171]
    v_mfma_f32_16x16x32_bf16 v[172:175], a[220:223], v[100:103], v[172:175]
    s_waitcnt vmcnt(7)
    v_mfma_f32_16x16x32_bf16 v[176:179], a[0:3], v[104:107], 0
    buffer_load_dwordx4 v[36:39], v11, s[32:35], s73 offen offset:2048 sc1
    v_mfma_f32_16x16x32_bf16 v[180:183], a[4:7], v[104:107], 0
    buffer_load_dword v24, off, s[32:35], s82 offset:2560 sc1
    v_mfma_f32_16x16x32_bf16 v[184:187], a[8:11], v[104:107], 0
    v_mfma_f32_16x16x32_bf16 v[188:191], a[12:15], v[104:107], 0
    s_waitcnt vmcnt(8)
    v_mfma_f32_16x16x32_bf16 v[176:179], a[16:19], v[108:111], v[176:179]
    buffer_load_dwordx4 v[40:43], v11, s[32:35], s74 offen offset:0 sc1
    v_mfma_f32_16x16x32_bf16 v[180:183], a[20:23], v[108:111], v[180:183]
    v_mfma_f32_16x16x32_bf16 v[184:187], a[24:27], v[108:111], v[184:187]
    v_mfma_f32_16x16x32_bf16 v[188:191], a[28:31], v[108:111], v[188:191]
    s_waitcnt vmcnt(8)
    v_mfma_f32_16x16x32_bf16 v[176:179], a[32:35], v[112:115], v[176:179]
    buffer_load_dwordx4 v[44:47], v11, s[32:35], s74 offen offset:2048 sc1
    v_mfma_f32_16x16x32_bf16 v[180:183], a[36:39], v[112:115], v[180:183]
    ds_write_b128 v18, v[160:163] offset:16384
    v_mfma_f32_16x16x32_bf16 v[184:187], a[40:43], v[112:115], v[184:187]
    ds_write_b128 v18, v[164:167] offset:17408
    v_mfma_f32_16x16x32_bf16 v[188:191], a[44:47], v[112:115], v[188:191]
    s_waitcnt vmcnt(8)
    v_mfma_f32_16x16x32_bf16 v[176:179], a[48:51], v[116:119], v[176:179]
    buffer_load_dwordx4 v[48:51], v11, s[32:35], s75 offen offset:0 sc1
    v_mfma_f32_16x16x32_bf16 v[180:183], a[52:55], v[116:119], v[180:183]
    ds_write_b128 v18, v[168:171] offset:18432
    v_mfma_f32_16x16x32_bf16 v[184:187], a[56:59], v[116:119], v[184:187]
    ds_write_b128 v18, v[172:175] offset:19456
    v_mfma_f32_16x16x32_bf16 v[188:191], a[60:63], v[116:119], v[188:191]
    s_waitcnt vmcnt(7)
    v_mfma_f32_16x16x32_bf16 v[176:179], a[64:67], v[120:123], v[176:179]
    buffer_load_dwordx4 v[52:55], v11, s[32:35], s75 offen offset:2048 sc1
    v_mfma_f32_16x16x32_bf16 v[180:183], a[68:71], v[120:123], v[180:183]
    v_mfma_f32_16x16x32_bf16 v[184:187], a[72:75], v[120:123], v[184:187]
    v_mfma_f32_16x16x32_bf16 v[188:191], a[76:79], v[120:123], v[188:191]
    s_waitcnt vmcnt(7)
    v_mfma_f32_16x16x32_bf16 v[176:179], a[80:83], v[124:127], v[176:179]
    buffer_load_dwordx4 v[56:59], v11, s[32:35], s76 offen offset:0 sc1
    v_mfma_f32_16x16x32_bf16 v[180:183], a[84:87], v[124:127], v[180:183]
    s_waitcnt lgkmcnt(0)
    s_barrier
    v_mfma_f32_16x16x32_bf16 v[184:187], a[88:91], v[124:127], v[184:187]
    ds_read_b128 v[192:195], v21 offset:16384
    v_mfma_f32_16x16x32_bf16 v[188:191], a[92:95], v[124:127], v[188:191]
    s_waitcnt vmcnt(7)
    v_mfma_f32_16x16x32_bf16 v[176:179], a[96:99], v[32:35], v[176:179]
    buffer_load_dwordx4 v[60:63], v11, s[32:35], s76 offen offset:2048 sc1
    v_mfma_f32_16x16x32_bf16 v[180:183], a[100:103], v[32:35], v[180:183]
    s_waitcnt vmcnt(6)
    v_cmp_eq_u32 vcc, s46, v24
    s_nop 0
    s_and_b32 s62, vcc_lo, s47
    s_cmp_eq_u32 s62, -1
    s_cbranch_scc0 PA_44
PD_45:
    buffer_load_dwordx4 v[232:235], v28, s[28:31], s86 offen sc1
    v_mfma_f32_16x16x32_bf16 v[184:187], a[104:107], v[32:35], v[184:187]
    buffer_load_dwordx4 v[236:239], v28, s[28:31], s94 offen sc1
    v_mfma_f32_16x16x32_bf16 v[188:191], a[108:111], v[32:35], v[188:191]
    v_mfma_f32_16x16x32_bf16 v[176:179], a[112:115], v[36:39], v[176:179]
    ds_read_b128 v[196:199], v21 offset:17408
    v_mfma_f32_16x16x32_bf16 v[180:183], a[116:119], v[36:39], v[180:183]
    ds_read_b128 v[200:203], v21 offset:18432
    v_mfma_f32_16x16x32_bf16 v[184:187], a[120:123], v[36:39], v[184:187]
    ds_read_b128 v[204:207], v21 offset:19456
    v_mfma_f32_16x16x32_bf16 v[188:191], a[124:127], v[36:39], v[188:191]
    s_waitcnt vmcnt(7)
L_STUB6:
    s_cbranch_execz L_BACK
    v_mfma_f32_16x16x32_bf16 v[176:179], a[128:131], v[40:43], v[176:179]
    v_mfma_f32_16x16x32_bf16 v[180:183], a[132:135], v[40:43], v[180:183]
    s_waitcnt lgkmcnt(0)
    v_mfma_f32_16x16x32_bf16 v[184:187], a[136:139], v[40:43], v[184:187]
    v_fmac_f32 v128, v192, v144
    v_fmac_f32 v129, v193, v145
    v_mfma_f32_16x16x32_bf16 v[188:191], a[140:143], v[40:43], v[188:191]
    s_waitcnt vmcnt(6)
    v_mfma_f32_16x16x32_bf16 v[176:179], a[144:147], v[44:47], v[176:179]
    v_fmac_f32 v130, v194, v146
    v_fmac_f32 v131, v195, v147
    v_mfma_f32_16x16x32_bf16 v[180:183], a[148:151], v[44:47], v[180:183]
    v_fmac_f32 v132, v196, v148
    v_fmac_f32 v133, v197, v149
    v_mfma_f32_16x16x32_bf16 v[184:187], a[152:155], v[44:47], v[184:187]
    v_fmac_f32 v134, v198, v150
    v_fmac_f32 v135, v199, v151
    v_mfma_f32_16x16x32_bf16 v[188:191], a[156:159], v[44:47], v[188:191]
    s_waitcnt vmcnt(5)
    v_mfma_f32_16x16x32_bf16 v[176:179], a[160:163], v[48:51], v[176:179]
    v_fmac_f32 v136, v200, v152
    v_fmac_f32 v137, v201, v153
    v_mfma_f32_16x16x32_bf16 v[180:183], a[164:167], v[48:51], v[180:183]
    v_fmac_f32 v138, v202, v154
    v_fmac_f32 v139, v203, v155
    v_mfma_f32_16x16x32_bf16 v[184:187], a[168:171], v[48:51], v[184:187]
    v_fmac_f32 v140, v204, v156
    v_fmac_f32 v141, v205, v157
    v_mfma_f32_16x16x32_bf16 v[188:191], a[172:175], v[48:51], v[188:191]
    s_waitcnt vmcnt(4)
    v_mfma_f32_16x16x32_bf16 v[176:179], a[176:179], v[52:55], v[176:179]
    v_fmac_f32 v142, v206, v158
    v_fmac_f32 v143, v207, v159
    v_mfma_f32_16x16x32_bf16 v[180:183], a[180:183], v[52:55], v[180:183]
    v_mfma_f32_16x16x32_bf16 v[184:187], a[184:187], v[52:55], v[184:187]
    v_mfma_f32_16x16x32_bf16 v[188:191], a[188:191], v[52:55], v[188:191]
    s_waitcnt vmcnt(3)
    v_mfma_f32_16x16x32_bf16 v[176:179], a[192:195], v[56:59], v[176:179]
    v_mfma_f32_16x16x32_bf16 v[180:183], a[196:199], v[56:59], v[180:183]
    v_mfma_f32_16x16x32_bf16 v[184:187], a[200:203], v[56:59], v[184:187]
    v_mfma_f32_16x16x32_bf16 v[188:191], a[204:207], v[56:59], v[188:191]
    s_waitcnt vmcnt(2)
    v_mfma_f32_16x16x32_bf16 v[176:179], a[208:211], v[60:63], v[176:179]
    v_mfma_f32_16x16x32_bf16 v[180:183], a[212:215], v[60:63], v[180:183]
    v_mfma_f32_16x16x32_bf16 v[184:187], a[216:219], v[60:63], v[184:187]
    v_mfma_f32_16x16x32_bf16 v[188:191], a[220:223], v[60:63], v[188:191]
    s_waitcnt vmcnt(0)
    v_lshlrev_b32 v192, 16, v232
    v_and_b32 v193, 0xffff0000, v232
    v_lshlrev_b32 v194, 16, v233
    v_and_b32 v195, 0xffff0000, v233
    v_lshlrev_b32 v196, 16, v234
    v_and_b32 v197, 0xffff0000, v234
    v_lshlrev_b32 v198, 16, v235
    v_and_b32 v199, 0xffff0000, v235
    v_lshlrev_b32 v200, 16, v236
    v_and_b32 v201, 0xffff0000, v236
    v_lshlrev_b32 v202, 16, v237
    v_and_b32 v203, 0xffff0000, v237
    v_lshlrev_b32 v204, 16, v238
    v_and_b32 v205, 0xffff0000, v238
    v_lshlrev_b32 v206, 16, v239
    v_and_b32 v207, 0xffff0000, v239
    v_pk_add_f32 v[176:177], v[176:177], v[192:193]
    v_pk_add_f32 v[178:179], v[178:179], v[194:195]
    v_pk_fma_f32 v[128:129], v[176:177], v[144:145], v[128:129]
    v_pk_fma_f32 v[130:131], v[178:179], v[146:147], v[130:131]
    v_cvt_pk_bf16_f32 v232, v128, v129
    v_cvt_pk_bf16_f32 v233, v130, v131
    ds_write_b64 v19, v[232:233] offset:0
    v_pk_add_f32 v[180:181], v[180:181], v[196:197]
    v_pk_add_f32 v[182:183], v[182:183], v[198:199]
    v_pk_fma_f32 v[132:133], v[180:181], v[148:149], v[132:133]
    v_pk_fma_f32 v[134:135], v[182:183], v[150:151], v[134:135]
    v_cvt_pk_bf16_f32 v234, v132, v133
    v_cvt_pk_bf16_f32 v235, v134, v135
    ds_write_b64 v19, v[234:235] offset:32
    v_pk_add_f32 v[184:185], v[184:185], v[200:201]
    v_pk_add_f32 v[186:187], v[186:187], v[202:203]
    v_pk_fma_f32 v[136:137], v[184:185], v[152:153], v[136:137]
    v_pk_fma_f32 v[138:139], v[186:187], v[154:155], v[138:139]
    v_cvt_pk_bf16_f32 v236, v136, v137
    v_cvt_pk_bf16_f32 v237, v138, v139
    ds_write_b64 v19, v[236:237] offset:64
    v_pk_add_f32 v[188:189], v[188:189], v[204:205]
    v_pk_add_f32 v[190:191], v[190:191], v[206:207]
    v_pk_fma_f32 v[140:141], v[188:189], v[156:157], v[140:141]
    v_pk_fma_f32 v[142:143], v[190:191], v[158:159], v[142:143]
    v_cvt_pk_bf16_f32 v238, v140, v141
    v_cvt_pk_bf16_f32 v239, v142, v143
    ds_write_b64 v19, v[238:239] offset:96
    ds_read_b128 v[208:211], v20 offset:0
    ds_read_b128 v[212:215], v20 offset:1152
    s_waitcnt lgkmcnt(1)
    buffer_store_dwordx4 v[208:211], v28, s[28:31], s86 offen
    s_waitcnt lgkmcnt(0)
    buffer_store_dwordx4 v[212:215], v28, s[28:31], s94 offen
    s_endpgm
L_IDLE:
L_STUB7:
    s_cbranch_execz L_BACK
    s_sub_u32 s66, s2, 224
    s_min_u32 s66, s66, 27
    v_and_b32 v32, 15, v0
    s_lshl_b32 s66, s66, 2
    s_add_u32 s66, s66, s44
    s_lshl_b32 s63, s66, 5
    v_lshl_add_u32 v33, v32, 1, s63
    global_load_ushort v34, v33, s[36:37]
    v_min_u32 v23, 223, v1
    v_lshlrev_b32 v23, 4, v23
    v_cmp_le_u32 vcc, 112, v1
    s_mov_b32 s80, 70912
    s_mov_b32 s81, 81664
    s_mov_b32 s82, 92416
    s_mov_b32 s83, 103168
    v_cndmask_b32 v38, 0, 1.0, vcc
    v_bfe_u32 v180, v3, 0, 8
    v_bfe_u32 v181, v3, 8, 8
    v_bfe_u32 v182, v3, 16, 8
    v_bfe_u32 v183, v3, 24, 8
    buffer_load_dwordx4 v[40:43], v23, s[32:35], s80 offen sc1
    buffer_load_dwordx4 v[44:47], v23, s[32:35], s81 offen sc1
    buffer_load_dwordx4 v[48:51], v23, s[32:35], s82 offen sc1
    buffer_load_dwordx4 v[52:55], v23, s[32:35], s83 offen sc1
    s_cmp_eq_u32 s47, 0
    s_cbranch_scc1 PS_46
    s_mov_b64 exec, 1
    s_waitcnt vmcnt(5)
    buffer_store_dword v3, off, s[32:35], s95
    s_mov_b64 exec, -1
PR_47:
    v_lshlrev_b32 v30, 7, v0
    s_lshr_b32 s77, s42, 3
    s_lshl_b32 s77, s77, 1
    s_and_b32 s78, s43, 1
    s_add_u32 s72, s77, s78
    s_mul_i32 s76, s78, 24576
    s_add_u32 s76, s76, s84
    s_add_u32 s71, s76, 32768
    s_lshl_b32 s77, s72, 2
    s_add_u32 s77, s77, s44
    s_and_b32 s78, s2, 7
    s_cmp_eq_u32 s78, 7
    s_cselect_b32 s78, 0, s78
    s_mul_i32 s78, s78, 28
    s_add_u32 s77, s77, s78
    s_lshl_b32 s70, s77, 13
    s_lshl_b32 s77, s42, 3
    s_and_b32 s78, s43, 1
    s_lshl_b32 s78, s78, 2
    s_add_u32 s77, s77, s78
    s_add_u32 s77, s77, s44
    s_mul_i32 s79, s77, 14336
    v_min_u32 v31, 7040, v30
    v_and_b32 v29, 15, v0
    v_min_u32 v29, 13, v29
    v_lshlrev_b32 v29, 8, v29
    v_lshrrev_b32 v25, 4, v0
    v_mul_u32_u24 v25, 3584, v25
    v_add_u32 v29, v29, v25
    s_mul_i32 s77, s44, 112
    s_and_b32 s78, s72, 1
    s_lshl_b32 s78, s78, 2
    s_add_u32 s77, s77, s78
    s_lshr_b32 s78, s72, 1
    s_mul_i32 s78, s78, 56
    s_add_u32 s78, s78, 32
    s_add_u32 s77, s77, s78
    s_mul_i32 s73, s77, 3584
    buffer_load_dword v26, v29, s[16:19], s73 offen
    s_add_u32 s73, s73, 28672
    buffer_load_dword v26, v29, s[16:19], s73 offen
    s_add_u32 s73, s73, 28672
    s_waitcnt vmcnt(3)
    s_nop 0
    v_bitop3_b32 v56, v40, v44, v180 bitop3:0x7e
    v_bitop3_b32 v60, v48, v52, v180 bitop3:0x7e
    v_bitop3_b32 v57, v41, v45, v181 bitop3:0x7e
    v_bitop3_b32 v61, v49, v53, v181 bitop3:0x7e
    v_bitop3_b32 v58, v42, v46, v182 bitop3:0x7e
    v_bitop3_b32 v62, v50, v54, v182 bitop3:0x7e
    v_bitop3_b32 v59, v43, v47, v183 bitop3:0x7e
    v_bitop3_b32 v63, v51, v55, v183 bitop3:0x7e
    v_or3_b32 v56, v56, v57, v58
    v_or3_b32 v59, v59, v60, v61
    v_or3_b32 v56, v56, v62, v63
    v_or_b32_e64 v56, v56, v59
    v_and_b32 v56, 0xff, v56
    v_cmp_eq_u32 vcc, 0, v56
    s_nop 0
    s_cmp_eq_u64 vcc, -1
    s_cbranch_scc0 RC_48
RB_49:
    v_and_b32 v40, 0xffffff00, v40
    v_and_b32 v41, 0xffffff00, v41
    v_and_b32 v42, 0xffffff00, v42
    v_and_b32 v43, 0xffffff00, v43
    v_and_b32 v44, 0xffffff00, v44
    v_and_b32 v45, 0xffffff00, v45
    v_and_b32 v46, 0xffffff00, v46
    v_and_b32 v47, 0xffffff00, v47
    v_and_b32 v48, 0xffffff00, v48
    v_and_b32 v49, 0xffffff00, v49
    v_and_b32 v50, 0xffffff00, v50
    v_and_b32 v51, 0xffffff00, v51
    v_and_b32 v52, 0xffffff00, v52
    v_and_b32 v53, 0xffffff00, v53
    v_and_b32 v54, 0xffffff00, v54
    v_and_b32 v55, 0xffffff00, v55
    v_pk_add_f32 v[40:41], v[40:41], v[48:49]
    v_pk_add_f32 v[42:43], v[42:43], v[50:51]
    v_pk_add_f32 v[44:45], v[44:45], v[52:53]
    v_pk_add_f32 v[46:47], v[46:47], v[54:55]
    v_pk_add_f32 v[40:41], v[40:41], v[44:45]
    v_pk_add_f32 v[42:43], v[42:43], v[46:47]
    v_cvt_pk_bf16_f32 v56, v40, v41
    v_cvt_pk_bf16_f32 v57, v42, v43
    v_lshlrev_b32 v40, 16, v56
    v_and_b32 v41, 0xffff0000, v56
    v_lshlrev_b32 v42, 16, v57
    v_and_b32 v43, 0xffff0000, v57
    v_pk_add_f32 v[40:41], v[40:41], v[38:39] op_sel_hi:[1,0]
    v_pk_add_f32 v[42:43], v[42:43], v[38:39] op_sel_hi:[1,0]
    v_cvt_pk_bf16_f32 v56, v40, v41
    v_cvt_pk_bf16_f32 v57, v42, v43
    v_lshlrev_b32 v33, 3, v1
    v_add_u32 v33, 154112, v33
    ds_write_b64 v33, v[56:57]
    v_lshlrev_b32 v33, 2, v1
    v_add_u32 v33, 154112, v33
    ds_write_b32 v33, v252 offset:2048
    ds_write_b32 v33, v230 offset:3072
    s_lshr_b32 s63, s66, 1
    s_lshl_b32 s63, s63, 10
    s_and_b32 s62, s66, 1
    s_lshl_b32 s62, s62, 8
    s_add_u32 s62, s62, s63
    s_add_u32 s68, s62, 131072
    s_cmp_lt_u32 s2, 252
    s_cselect_b32 s68, s68, 16777216
    v_mov_b32 v33, 3072
    v_cmp_eq_u32 vcc, 0, v32
    v_mov_b32 v35, 896
    s_nop 0
    v_cndmask_b32 v33, v33, v35, vcc
    v_cmp_eq_u32 vcc, 1, v32
    v_mov_b32 v35, 0
    s_nop 0
    v_cndmask_b32 v33, v33, v35, vcc
    v_cmp_eq_u32 vcc, 4, v32
    v_mov_b32 v35, 2048
    s_nop 0
    v_cndmask_b32 v33, v33, v35, vcc
    v_lshrrev_b32 v35, 5, v0
    v_lshl_add_u32 v33, v35, 5, v33
    v_bfe_u32 v35, v0, 4, 1
    v_lshl_add_u32 v33, v35, 3, v33
    v_add_u32 v33, 154112, v33
    s_lshl_b32 s62, s44, 5
    v_xor_b32 v35, s62, v12
    v_add_u32 v35, 86016, v35
    s_waitcnt lgkmcnt(0)
    s_barrier
    ds_read_b64 v[80:81], v33 offset:0
    ds_read_b64_tr_b16 v[96:97], v35 offset:0
    ds_read_b64 v[82:83], v33 offset:16
    ds_read_b64_tr_b16 v[98:99], v35 offset:1024
    ds_read_b64 v[84:85], v33 offset:64
    ds_read_b64_tr_b16 v[100:101], v35 offset:4096
    ds_read_b64 v[86:87], v33 offset:80
    ds_read_b64_tr_b16 v[102:103], v35 offset:5120
    ds_read_b64 v[88:89], v33 offset:128
    ds_read_b64_tr_b16 v[104:105], v35 offset:8192
    ds_read_b64 v[90:91], v33 offset:144
    ds_read_b64_tr_b16 v[106:107], v35 offset:9216
    s_waitcnt lgkmcnt(8)
    v_mfma_f32_16x16x32_bf16 v[64:67], v[80:83], v[96:99], 0
    ds_read_b64 v[80:81], v33 offset:192
    ds_read_b64_tr_b16 v[96:97], v35 offset:12288
    ds_read_b64 v[82:83], v33 offset:208
    ds_read_b64_tr_b16 v[98:99], v35 offset:13312
    s_waitcnt lgkmcnt(8)
    v_mfma_f32_16x16x32_bf16 v[64:67], v[84:87], v[100:103], v[64:67]
    ds_read_b64 v[84:85], v33 offset:256
    ds_read_b64_tr_b16 v[100:101], v35 offset:16384
    ds_read_b64 v[86:87], v33 offset:272
    ds_read_b64_tr_b16 v[102:103], v35 offset:17408
    s_waitcnt lgkmcnt(8)
    v_mfma_f32_16x16x32_bf16 v[64:67], v[88:91], v[104:107], v[64:67]
    ds_read_b64 v[88:89], v33 offset:320
    ds_read_b64_tr_b16 v[104:105], v35 offset:20480
    ds_read_b64 v[90:91], v33 offset:336
    ds_read_b64_tr_b16 v[106:107], v35 offset:21504
    s_waitcnt lgkmcnt(8)
    v_mfma_f32_16x16x32_bf16 v[64:67], v[80:83], v[96:99], v[64:67]
    ds_read_b64 v[80:81], v33 offset:384
    ds_read_b64_tr_b16 v[96:97], v35 offset:24576
    ds_read_b64 v[82:83], v33 offset:400
    ds_read_b64_tr_b16 v[98:99], v35 offset:25600
    s_waitcnt lgkmcnt(8)
    v_mfma_f32_16x16x32_bf16 v[64:67], v[84:87], v[100:103], v[64:67]
    ds_read_b64 v[84:85], v33 offset:448
    ds_read_b64_tr_b16 v[100:101], v35 offset:28672
    ds_read_b64 v[86:87], v33 offset:464
    ds_read_b64_tr_b16 v[102:103], v35 offset:29696
    s_waitcnt lgkmcnt(8)
    v_mfma_f32_16x16x32_bf16 v[64:67], v[88:91], v[104:107], v[64:67]
    ds_read_b64 v[88:89], v33 offset:512
    ds_read_b64_tr_b16 v[104:105], v35 offset:32768
    ds_read_b64 v[90:91], v33 offset:528
    ds_read_b64_tr_b16 v[106:107], v35 offset:33792
    s_waitcnt lgkmcnt(8)
    v_mfma_f32_16x16x32_bf16 v[64:67], v[80:83], v[96:99], v[64:67]
    ds_read_b64 v[80:81], v33 offset:576
    ds_read_b64_tr_b16 v[96:97], v35 offset:36864
    ds_read_b64 v[82:83], v33 offset:592
    ds_read_b64_tr_b16 v[98:99], v35 offset:37888
    s_waitcnt lgkmcnt(8)
    v_mfma_f32_16x16x32_bf16 v[64:67], v[84:87], v[100:103], v[64:67]
    ds_read_b64 v[84:85], v33 offset:640
    ds_read_b64_tr_b16 v[100:101], v35 offset:40960
    ds_read_b64 v[86:87], v33 offset:656
    ds_read_b64_tr_b16 v[102:103], v35 offset:41984
    s_waitcnt lgkmcnt(8)
    v_mfma_f32_16x16x32_bf16 v[64:67], v[88:91], v[104:107], v[64:67]
    ds_read_b64 v[88:89], v33 offset:704
    ds_read_b64_tr_b16 v[104:105], v35 offset:45056
    ds_read_b64 v[90:91], v33 offset:720
    ds_read_b64_tr_b16 v[106:107], v35 offset:46080
    s_waitcnt lgkmcnt(8)
    v_mfma_f32_16x16x32_bf16 v[64:67], v[80:83], v[96:99], v[64:67]
    ds_read_b64 v[80:81], v33 offset:768
    ds_read_b64_tr_b16 v[96:97], v35 offset:49152
    ds_read_b64 v[82:83], v33 offset:784
    ds_read_b64_tr_b16 v[98:99], v35 offset:50176
    s_waitcnt lgkmcnt(8)
    v_mfma_f32_16x16x32_bf16 v[64:67], v[84:87], v[100:103], v[64:67]
    ds_read_b64 v[84:85], v33 offset:832
    ds_read_b64_tr_b16 v[100:101], v35 offset:53248
    ds_read_b64 v[86:87], v33 offset:848
    ds_read_b64_tr_b16 v[102:103], v35 offset:54272
    s_waitcnt lgkmcnt(8)
    v_mfma_f32_16x16x32_bf16 v[64:67], v[88:91], v[104:107], v[64:67]
    s_waitcnt lgkmcnt(4)
    v_mfma_f32_16x16x32_bf16 v[64:67], v[80:83], v[96:99], v[64:67]
    s_waitcnt lgkmcnt(0)
    v_mfma_f32_16x16x32_bf16 v[64:67], v[84:87], v[100:103], v[64:67]
    v_cmp_gt_u32 vcc, 16, v0
    v_lshlrev_b32 v34, 16, v34
    v_mov_b32 v43, s40
    s_nop 4
    v_cndmask_b32 v65, v34, v65, vcc
    v_cvt_pk_bf16_f32 v41, v64, v65
    v_lshlrev_b32 v44, 16, v41
    v_and_b32 v45, 0xffff0000, v41
    v_sub_f32 v46, v64, v44
    v_sub_f32 v47, v65, v45
    v_cvt_pk_bf16_f32 v40, v44, v46
    v_cvt_pk_bf16_f32 v42, v47, v45
    s_mov_b32 exec_hi, 0
    buffer_store_dwordx4 v[40:43], v27, s[32:35], s68 offen sc1
    s_mov_b64 exec, -1
    buffer_load_dword v26, v29, s[16:19], s73 offen
    s_add_u32 s73, s73, 28672
    buffer_load_dword v26, v30, s[32:35], s71 offen sc1
    s_add_u32 s71, s71, 8192
    buffer_load_dword v26, v30, s[20:23], s70 offen
    s_add_u32 s70, s70, 131072
    s_sub_u32 s75, s70, 1605632
    s_cselect_b32 s70, s70, s75
    buffer_load_dword v26, v30, s[20:23], s70 offen
    s_add_u32 s70, s70, 131072
    s_sub_u32 s75, s70, 1605632
    s_cselect_b32 s70, s70, s75
    buffer_load_dword v26, v30, s[20:23], s70 offen
    s_add_u32 s70, s70, 131072
    s_sub_u32 s75, s70, 1605632
    s_cselect_b32 s70, s70, s75
    buffer_load_dword v26, v30, s[20:23], s70 offen
    s_add_u32 s70, s70, 131072
    s_sub_u32 s75, s70, 1605632
    s_cselect_b32 s70, s70, s75
    buffer_load_dword v26, v30, s[20:23], s70 offen
    s_add_u32 s70, s70, 131072
    s_sub_u32 s75, s70, 1605632
    s_cselect_b32 s70, s70, s75
    buffer_load_dword v26, v30, s[20:23], s70 offen
    s_add_u32 s70, s70, 131072
    s_sub_u32 s75, s70, 1605632
    s_cselect_b32 s70, s70, s75
    buffer_load_dword v26, v30, s[32:35], s71 offen sc1
    s_add_u32 s71, s71, 8192
    buffer_load_dword v26, v30, s[32:35], s71 offen sc1
    s_add_u32 s71, s71, 8192
    buffer_load_dword v26, v31, s[28:31], s79 offen sc1
    s_add_u32 s79, s79, 7168
    buffer_load_dword v26, v31, s[28:31], s79 offen sc1
    s_add_u32 s79, s79, 7168
    s_lshl_b32 s62, s44, 8
    s_add_u32 s62, s62, s2
    s_cmp_eq_u32 s62, 1023
    s_cbranch_scc0 SK_50
    v_lshlrev_b32 v23, 9, v0
    s_mov_b32 s62, 229376
    s_mov_b32 s53, 40000
PL_51:
    buffer_load_dword v40, v23, s[32:35], s62 offen offset:0 sc1
    buffer_load_dword v41, v23, s[32:35], s62 offen offset:128 sc1
    buffer_load_dword v42, v23, s[32:35], s62 offen offset:256 sc1
    buffer_load_dword v43, v23, s[32:35], s62 offen offset:384 sc1
    s_sub_u32 s53, s53, 1
    s_cbranch_scc1 L_END
    s_waitcnt vmcnt(0)
    v_xor_b32 v40, s46, v40
    v_xor_b32 v41, s46, v41
    v_xor_b32 v42, s46, v42
    v_xor_b32 v43, s46, v43
    v_or3_b32 v40, v40, v41, v42
    v_or_b32 v40, v40, v43
    v_cmp_gt_u32 vcc, 8, v40
    s_nop 0
    s_cmp_eq_u64 vcc, -1
    s_cbranch_scc0 PL_51
    s_mov_b64 exec, 1
    buffer_store_dword v3, off, s[32:35], 0 sc1
    s_mov_b64 exec, -1
SK_50:
    s_endpgm
L_STUB8:
    s_cbranch_execz L_BACK
    s_endpgm
WV_9:
    s_mov_b32 s53, 40000
WV_9_l:
    s_add_u32 m0, s88, s75
    s_add_u32 s71, s70, s75
    buffer_load_dwordx4 v2, s[32:35], s71 offen offset:0 sc1 lds
    buffer_load_dwordx4 v2, s[32:35], s71 offen offset:1024 sc1 lds
    buffer_load_dwordx4 v2, s[32:35], s71 offen offset:2048 sc1 lds
    buffer_load_dwordx4 v2, s[32:35], s71 offen offset:3072 sc1 lds
    s_add_u32 m0, s88, s76
    s_add_u32 s71, s70, s76
    buffer_load_dwordx4 v2, s[32:35], s71 offen offset:0 sc1 lds
    buffer_load_dwordx4 v2, s[32:35], s71 offen offset:1024 sc1 lds
    buffer_load_dwordx4 v2, s[32:35], s71 offen offset:2048 sc1 lds
    buffer_load_dwordx4 v2, s[32:35], s71 offen offset:3072 sc1 lds
    s_waitcnt vmcnt(0)
    v_add_u32 v208, s75, v19
    ds_read_b64 v[196:197], v208
    v_add_u32 v208, s76, v19
    ds_read_b64 v[198:199], v208
    s_waitcnt lgkmcnt(0)
    v_bitop3_b32 v196, v197, v199, s40 bitop3:0x7e
    v_cmp_eq_u32 vcc, 0, v196
    s_nop 1
    s_cmp_eq_u64 vcc, -1
    s_cbranch_scc1 WR_10
    s_sub_u32 s53, s53, 1
    s_cbranch_scc0 WV_9_l
    s_endpgm
PA_22:
    s_cmp_eq_u32 s47, 0
    s_cbranch_scc1 PA_22_s
    s_mov_b32 s53, 40000
PA_22_f:
    buffer_load_dword v24, v23, s[32:35], 0 offen offset:0 sc1
    s_sub_u32 s53, s53, 1
    s_cbranch_scc1 L_END
    s_waitcnt vmcnt(1)
    v_cmp_eq_u32 vcc, s46, v26
    s_nop 0
    s_cmp_eq_u32 vcc_lo, -1
    s_cbranch_scc1 PD_23
    buffer_load_dword v26, v23, s[32:35], 0 offen offset:0 sc1
    s_sub_u32 s53, s53, 1
    s_cbranch_scc1 L_END
    s_waitcnt vmcnt(1)
    v_cmp_eq_u32 vcc, s46, v24
    s_nop 0
    s_cmp_eq_u32 vcc_lo, -1
    s_cbranch_scc1 PD_23
    s_branch PA_22_f
PA_28:
    s_cmp_eq_u32 s47, 0
    s_cbranch_scc1 PA_28_s
    s_mov_b32 s53, 40000
PA_28_f:
    buffer_load_dword v24, v29, s[32:35], s90 offen offset:768 sc1
    s_sub_u32 s53, s53, 1
    s_cbranch_scc1 L_END
    s_waitcnt vmcnt(1)
    v_cmp_eq_u32 vcc, s46, v26
    s_nop 0
    s_cmp_eq_u32 vcc_lo, -1
    s_cbranch_scc1 PD_29
    buffer_load_dword v26, v29, s[32:35], s90 offen offset:768 sc1
    s_sub_u32 s53, s53, 1
    s_cbranch_scc1 L_END
    s_waitcnt vmcnt(1)
    v_cmp_eq_u32 vcc, s46, v24
    s_nop 0
    s_cmp_eq_u32 vcc_lo, -1
    s_cbranch_scc1 PD_29
    s_branch PA_28_f
PA_32:
    s_cmp_eq_u32 s47, 0
    s_cbranch_scc1 PA_32_s
    s_mov_b32 s53, 40000
PA_32_f:
    buffer_load_dword v24, v29, s[32:35], s90 offen offset:2048 sc1
    s_sub_u32 s53, s53, 1
    s_cbranch_scc1 L_END
    s_waitcnt vmcnt(0)
    v_cmp_eq_u32 vcc, s46, v24
    s_nop 0
    s_cmp_eq_u32 vcc_lo, -1
    s_cbranch_scc1 PD_33
    s_branch PA_32_f
PA_40:
    s_cmp_eq_u32 s47, 0
    s_cbranch_scc1 PA_40_s
    s_mov_b32 s53, 40000
PA_40_f:
    buffer_load_dword v24, v23, s[32:35], s91 offen offset:1280 sc1
    s_sub_u32 s53, s53, 1
    s_cbranch_scc1 L_END
    s_waitcnt vmcnt(1)
    v_cmp_eq_u32 vcc, s46, v26
    s_nop 0
    s_cmp_eq_u32 vcc_lo, -1
    s_cbranch_scc1 PD_41
    buffer_load_dword v26, v23, s[32:35], s91 offen offset:1280 sc1
    s_sub_u32 s53, s53, 1
    s_cbranch_scc1 L_END
    s_waitcnt vmcnt(1)
    v_cmp_eq_u32 vcc, s46, v24
    s_nop 0
    s_cmp_eq_u32 vcc_lo, -1
    s_cbranch_scc1 PD_41
    s_branch PA_40_f
PA_44:
    s_cmp_eq_u32 s47, 0
    s_cbranch_scc1 PA_44_s
    s_mov_b32 s53, 40000
PA_44_f:
    buffer_load_dword v24, off, s[32:35], s82 offset:2560 sc1
    s_sub_u32 s53, s53, 1
    s_cbranch_scc1 L_END
    s_waitcnt vmcnt(0)
    v_cmp_eq_u32 vcc, s46, v24
    s_nop 0
    s_cmp_eq_u32 vcc_lo, -1
    s_cbranch_scc1 PD_45
    s_branch PA_44_f
WV_11:
    s_mov_b32 s53, 40000
WV_11_l:
    s_add_u32 m0, s88, s75
    s_add_u32 s71, s70, s75
    buffer_load_dwordx4 v2, s[32:35], s71 offen offset:0 sc1 lds
    buffer_load_dwordx4 v2, s[32:35], s71 offen offset:1024 sc1 lds
    buffer_load_dwordx4 v2, s[32:35], s71 offen offset:2048 sc1 lds
    buffer_load_dwordx4 v2, s[32:35], s71 offen offset:3072 sc1 lds
    s_add_u32 m0, s88, s76
    s_add_u32 s71, s70, s76
    buffer_load_dwordx4 v2, s[32:35], s71 offen offset:0 sc1 lds
    buffer_load_dwordx4 v2, s[32:35], s71 offen offset:1024 sc1 lds
    buffer_load_dwordx4 v2, s[32:35], s71 offen offset:2048 sc1 lds
    buffer_load_dwordx4 v2, s[32:35], s71 offen offset:3072 sc1 lds
    s_add_u32 m0, s88, s77
    s_add_u32 s71, s70, s77
    buffer_load_dwordx4 v2, s[32:35], s71 offen offset:0 sc1 lds
    buffer_load_dwordx4 v2, s[32:35], s71 offen offset:1024 sc1 lds
    buffer_load_dwordx4 v2, s[32:35], s71 offen offset:2048 sc1 lds
    buffer_load_dwordx4 v2, s[32:35], s71 offen offset:3072 sc1 lds
    s_add_u32 m0, s88, s78
    s_add_u32 s71, s70, s78
    buffer_load_dwordx4 v2, s[32:35], s71 offen offset:0 sc1 lds
    buffer_load_dwordx4 v2, s[32:35], s71 offen offset:1024 sc1 lds
    buffer_load_dwordx4 v2, s[32:35], s71 offen offset:2048 sc1 lds
    buffer_load_dwordx4 v2, s[32:35], s71 offen offset:3072 sc1 lds
    s_add_u32 m0, s88, s79
    s_add_u32 s71, s70, s79
    buffer_load_dwordx4 v2, s[32:35], s71 offen offset:0 sc1 lds
    buffer_load_dwordx4 v2, s[32:35], s71 offen offset:1024 sc1 lds
    buffer_load_dwordx4 v2, s[32:35], s71 offen offset:2048 sc1 lds
    buffer_load_dwordx4 v2, s[32:35], s71 offen offset:3072 sc1 lds
    s_add_u32 m0, s88, 20480
    s_add_u32 s71, s70, 20480
    buffer_load_dwordx4 v2, s[32:35], s71 offen offset:0 sc1 lds
    s_waitcnt vmcnt(0)
    v_add_u32 v208, s75, v19
    ds_read_b64 v[196:197], v208
    v_add_u32 v208, s76, v19
    ds_read_b64 v[198:199], v208
    v_add_u32 v208, s77, v19
    ds_read_b64 v[200:201], v208
    v_add_u32 v208, s78, v19
    ds_read_b64 v[202:203], v208
    v_add_u32 v208, s79, v19
    ds_read_b64 v[204:205], v208
    ds_read_b64 v[206:207], v19 offset:17408
    s_waitcnt lgkmcnt(0)
    v_bitop3_b32 v196, v197, v199, s40 bitop3:0x7e
    v_bitop3_b32 v200, v201, v203, s40 bitop3:0x7e
    v_bitop3_b32 v204, v205, v207, s40 bitop3:0x7e
    v_or3_b32 v196, v196, v200, v204
    v_cmp_eq_u32 vcc, 0, v196
    s_nop 1
    s_cmp_eq_u64 vcc, -1
    s_cbranch_scc1 WR_12
    s_sub_u32 s53, s53, 1
    s_cbranch_scc0 WV_11_l
    s_endpgm
HS_17:
    s_mov_b32 s47, 0
    s_cmp_lt_u32 s43, 9
    s_cbranch_scc0 HN_16
    buffer_wbl2 sc1
    s_add_u32 s62, s41, 3072
    s_waitcnt vmcnt(0)
    s_mov_b64 exec, 1
    buffer_store_dword v3, off, s[32:35], s62 sc1
    s_mov_b64 exec, -1
HN_16:
    s_mov_b32 s62, 3072
    s_mov_b32 s53, 40000
HS_17_l:
    buffer_load_dword v24, v184, s[32:35], s62 offen offset:0 sc1
    s_sub_u32 s53, s53, 1
    s_cbranch_scc1 L_END
    s_waitcnt vmcnt(0)
    v_cmp_eq_u32 vcc, s46, v24
    s_nop 1
    s_cmp_eq_u32 vcc_lo, -1
    s_cbranch_scc0 HS_17_l
    buffer_inv sc1
    s_waitcnt vmcnt(0)
    s_branch PD_14
RC_18:
    s_mov_b32 s53, 40000
RC_18_l:
    s_mov_b32 s67, 69120
    buffer_load_dword v148, v31, s[32:35], s67 offen sc1
    s_mov_b32 s67, 79872
    buffer_load_dword v149, v31, s[32:35], s67 offen sc1
    s_mov_b32 s67, 90624
    buffer_load_dword v150, v31, s[32:35], s67 offen sc1
    s_mov_b32 s67, 101376
    buffer_load_dword v151, v31, s[32:35], s67 offen sc1
    s_waitcnt vmcnt(0)
    v_bitop3_b32 v155, v148, v149, v154 bitop3:0x7e
    v_bitop3_b32 v156, v150, v151, v154 bitop3:0x7e
    v_or_b32 v155, v155, v156
    v_and_b32 v155, 0xff, v155
    v_cmp_eq_u32 vcc, 0, v155
    s_nop 1
    s_cmp_eq_u64 vcc, -1
    s_cbranch_scc1 RB_19
    s_sub_u32 s53, s53, 1
    s_cbranch_scc0 RC_18_l
    s_endpgm
PS_20:
    s_waitcnt vmcnt(0)
    buffer_wbl2 sc1
    s_waitcnt vmcnt(0)
    s_mov_b64 exec, 1
    buffer_store_dword v3, off, s[32:35], s95 sc1
    s_mov_b64 exec, -1
    s_branch PR_21
PA_22_s:
    s_mov_b32 s53, 40000
PA_22_l:
    buffer_load_dword v24, v23, s[32:35], 0 offen offset:0 sc1
    s_sub_u32 s53, s53, 1
    s_cbranch_scc1 L_END
    s_waitcnt vmcnt(0)
    v_cmp_eq_u32 vcc, s46, v24
    s_nop 1
    s_cmp_eq_u32 vcc_lo, -1
    s_cbranch_scc0 PA_22_l
    buffer_inv sc1
    s_waitcnt vmcnt(0)
    s_branch PD_23
PS_24:
    s_waitcnt vmcnt(0)
    buffer_wbl2 sc1
    s_waitcnt vmcnt(0)
    s_mov_b64 exec, 1
    buffer_store_dword v3, off, s[32:35], s13 offset:768 sc1
    s_mov_b64 exec, -1
    s_branch PR_25
PS_26:
    s_waitcnt vmcnt(0)
    buffer_wbl2 sc1
    s_waitcnt vmcnt(0)
    s_mov_b64 exec, 1
    buffer_store_dword v3, off, s[32:35], s13 offset:2048 sc1
    s_mov_b64 exec, -1
    s_branch PR_27
PA_28_s:
    s_mov_b32 s53, 40000
PA_28_l:
    buffer_load_dword v24, v29, s[32:35], s90 offen offset:768 sc1
    s_sub_u32 s53, s53, 1
    s_cbranch_scc1 L_END
    s_waitcnt vmcnt(0)
    v_cmp_eq_u32 vcc, s46, v24
    s_nop 1
    s_cmp_eq_u32 vcc_lo, -1
    s_cbranch_scc0 PA_28_l
    buffer_inv sc1
    s_waitcnt vmcnt(0)
    s_branch PD_29
RC_30:
    s_mov_b32 s53, 40000
RC_30_l:
    buffer_load_dwordx4 v[232:235], v2, s[32:35], s24 offen offset:0 sc1
    buffer_load_dwordx4 v[236:239], v2, s[32:35], s24 offen offset:1024 sc1
    buffer_load_dwordx4 v[240:243], v2, s[32:35], s24 offen offset:2048 sc1
    buffer_load_dwordx4 v[244:247], v2, s[32:35], s24 offen offset:3072 sc1
    s_waitcnt vmcnt(0)
    v_bitop3_b32 v24, v235, v239, s40 bitop3:0x7e
    v_bitop3_b32 v251, v243, v247, s40 bitop3:0x7e
    v_or_b32 v251, v24, v251
    v_cmp_eq_u32 vcc, 0, v251
    s_nop 1
    s_cmp_eq_u64 vcc, -1
    s_cbranch_scc1 RB_31
    s_sub_u32 s53, s53, 1
    s_cbranch_scc0 RC_30_l
    s_endpgm
PA_32_s:
    s_mov_b32 s53, 40000
PA_32_l:
    buffer_load_dword v24, v29, s[32:35], s90 offen offset:2048 sc1
    s_sub_u32 s53, s53, 1
    s_cbranch_scc1 L_END
    s_waitcnt vmcnt(0)
    v_cmp_eq_u32 vcc, s46, v24
    s_nop 1
    s_cmp_eq_u32 vcc_lo, -1
    s_cbranch_scc0 PA_32_l
    buffer_inv sc1
    s_waitcnt vmcnt(0)
    s_branch PD_33
SG_34:
    buffer_store_dword v3, off, s[32:35], s26 offset:1536 sc1
    s_branch SR_35
RC_36:
    s_mov_b32 s53, 40000
RC_36_l:
    buffer_load_dword v24, v29, s[32:35], s90 offen offset:1536 sc1
    s_waitcnt vmcnt(0)
    v_cmp_eq_u32 vcc, s46, v24
    s_nop 1
    s_cmp_eq_u64 vcc, -1
    s_cbranch_scc1 RB_37
    s_sub_u32 s53, s53, 1
    s_cbranch_scc0 RC_36_l
    s_endpgm
PS_38:
    s_waitcnt vmcnt(0)
    buffer_wbl2 sc1
    s_waitcnt vmcnt(0)
    s_mov_b64 exec, 1
    buffer_store_dword v3, off, s[32:35], s27 sc1
    s_mov_b64 exec, -1
    s_branch PR_39
PA_40_s:
    s_mov_b32 s53, 40000
PA_40_l:
    buffer_load_dword v24, v23, s[32:35], s91 offen offset:1280 sc1
    s_sub_u32 s53, s53, 1
    s_cbranch_scc1 L_END
    s_waitcnt vmcnt(0)
    v_cmp_eq_u32 vcc, s46, v24
    s_nop 1
    s_cmp_eq_u32 vcc_lo, -1
    s_cbranch_scc0 PA_40_l
    buffer_inv sc1
    s_waitcnt vmcnt(0)
    s_branch PD_41
PS_42:
    s_waitcnt vmcnt(0)
    buffer_wbl2 sc1
    s_waitcnt vmcnt(0)
    s_mov_b64 exec, 1
    buffer_store_dword v3, off, s[32:35], s81 offset:2560 sc1
    s_mov_b64 exec, -1
    s_branch PR_43
PA_44_s:
    s_mov_b32 s53, 40000
PA_44_l:
    buffer_load_dword v24, off, s[32:35], s82 offset:2560 sc1
    s_sub_u32 s53, s53, 1
    s_cbranch_scc1 L_END
    s_waitcnt vmcnt(0)
    v_cmp_eq_u32 vcc, s46, v24
    s_nop 1
    s_cmp_eq_u32 vcc_lo, -1
    s_cbranch_scc0 PA_44_l
    buffer_inv sc1
    s_waitcnt vmcnt(0)
    s_branch PD_45
PS_46:
    s_waitcnt vmcnt(0)
    buffer_wbl2 sc1
    s_waitcnt vmcnt(0)
    s_mov_b64 exec, 1
    buffer_store_dword v3, off, s[32:35], s95 sc1
    s_mov_b64 exec, -1
    s_branch PR_47
RC_48:
    s_mov_b32 s53, 40000
RC_48_l:
    buffer_load_dwordx4 v[40:43], v23, s[32:35], s80 offen sc1
    buffer_load_dwordx4 v[44:47], v23, s[32:35], s81 offen sc1
    buffer_load_dwordx4 v[48:51], v23, s[32:35], s82 offen sc1
    buffer_load_dwordx4 v[52:55], v23, s[32:35], s83 offen sc1
    s_waitcnt vmcnt(0)
    s_nop 0
    v_bitop3_b32 v56, v40, v44, v180 bitop3:0x7e
    v_bitop3_b32 v60, v48, v52, v180 bitop3:0x7e
    v_bitop3_b32 v57, v41, v45, v181 bitop3:0x7e
    v_bitop3_b32 v61, v49, v53, v181 bitop3:0x7e
    v_bitop3_b32 v58, v42, v46, v182 bitop3:0x7e
    v_bitop3_b32 v62, v50, v54, v182 bitop3:0x7e
    v_bitop3_b32 v59, v43, v47, v183 bitop3:0x7e
    v_bitop3_b32 v63, v51, v55, v183 bitop3:0x7e
    v_or3_b32 v56, v56, v57, v58
    v_or3_b32 v59, v59, v60, v61
    v_or3_b32 v56, v56, v62, v63
    v_or_b32 v56, v56, v59
    v_and_b32 v56, 0xff, v56
    v_cmp_eq_u32 vcc, 0, v56
    s_nop 1
    s_cmp_eq_u64 vcc, -1
    s_cbranch_scc1 RB_49
    s_sub_u32 s53, s53, 1
    s_cbranch_scc0 RC_48_l
    s_endpgm
L_END:
    s_endpgm
.section .rodata,"a"
.p2align 6
.amdhsa_kernel adaLN_cond__sliding_local_dilated__mixer_channel_mlp__prompt_kernel
  .amdhsa_next_free_vgpr 512
  .amdhsa_next_free_sgpr 102
  .amdhsa_accum_offset 256
  .amdhsa_group_segment_fixed_size 0
  .amdhsa_kernarg_size 104
  .amdhsa_user_sgpr_count 2
  .amdhsa_user_sgpr_kernarg_segment_ptr 1
  .amdhsa_system_sgpr_workgroup_id_x 1
  .amdhsa_float_denorm_mode_32 3
.end_amdhsa_kernel
```
